```python
import torch

def _softmax(x, axis=-1):
    return torch.softmax(x, dim=axis)

def _gelu(x):
    return torch.nn.functional.gelu(x, approximate='tanh')

def _silu(x):
    return torch.nn.functional.silu(x)

def _sigmoid(x):
    return torch.sigmoid(x)

def _layernorm(x, axis=-1, eps=1e-05):
    m = x.mean(dim=axis, keepdim=True)
    v = x.var(dim=axis, keepdim=True, unbiased=False)
    return (x - m) / torch.sqrt(v + eps)

def _scatter_add(tgt, idx, src, axis=0):
    return tgt.clone().index_add_(axis, idx, src)

def _segment_sum(src, seg, n):
    out = torch.zeros((n,) + src.shape[1:], dtype=src.dtype)
    return out.index_add_(0, seg, src)

def _pad(x, pw):
    flat = tuple((v for pair in reversed(pw) for v in pair))
    return torch.nn.functional.pad(x, flat)
kernel_name = 'adaLN_cond__gqa_block_cached__swiglu_ffn__decode'

def setup_inputs():

    _w = lambda a: (lambda t: t.to(torch.bfloat16) if t.is_floating_point() else t)(torch.as_tensor(a))

    def _A_setup():
        B, Sq, D = (4, 1, 512)
        Hq, Hkv, Sk, Dh = (32, 8, 4096, 128)
        assert Hq % Hkv == 0, (Hq, Hkv)
        return {'x': _w((lambda *s: torch.randn(*s, dtype=torch.bfloat16) * 0.05)(B, Sq, D)), 'k_cache': _w((lambda *s: torch.randn(*s, dtype=torch.bfloat16) * 3.2)(B, Hkv, Sk, Dh)), 'v_cache': _w((lambda *s: torch.randn(*s, dtype=torch.bfloat16) * 0.4)(B, Hkv, Sk, Dh)), 'wq': _w((lambda *s: torch.randn(*s, dtype=torch.bfloat16) * 3.2)(D, Hq * Dh) * D ** (-0.5)), 'wo': _w((lambda *s: torch.randn(*s, dtype=torch.bfloat16) * 0.4)(Hq * Dh, D) * (Hq * Dh) ** (-0.5))}
    _A_in = _A_setup()

    def _B_setup():
        B, S, D, F = (4, 1, 512, 1792)
        return {'x': _w((lambda *s: torch.randn(*s, dtype=torch.bfloat16) * 0.05)(B, S, D)), 'w_gate': _w((lambda *s: torch.randn(*s, dtype=torch.bfloat16) * 0.05)(D, F)), 'w_up': _w((lambda *s: torch.randn(*s, dtype=torch.bfloat16) * 0.05)(D, F)), 'w_down': _w((lambda *s: torch.randn(*s, dtype=torch.bfloat16) * 0.05)(F, D))}
    _B_in = _B_setup()
    return {'A_x': _A_in['x'], 'A_k_cache': _A_in['k_cache'], 'A_v_cache': _A_in['v_cache'], 'A_wq': _A_in['wq'], 'A_wo': _A_in['wo'], 'B_x': _B_in['x'], 'B_w_gate': _B_in['w_gate'], 'B_w_up': _B_in['w_up'], 'B_w_down': _B_in['w_down'], 'c': _w((lambda *s: torch.randn(*s, dtype=torch.bfloat16) * 0.2)(4, 512) * 8.0), 'w_mod': _w((lambda *s: torch.randn(*s, dtype=torch.bfloat16) * 0.2)(512, 6 * 512) * 512 ** (-0.5) * 8.0)}

def reference(A_x, A_k_cache, A_v_cache, A_wq, A_wo, B_x, B_w_gate, B_w_up, B_w_down, c, w_mod):

    def _A_ref(x, k_cache, v_cache, wq, wo):
        B, Sq, D = x.shape
        Hq, Dh = (32, 128)
        Hkv = k_cache.shape[1]
        rep = Hq // Hkv
        q = (lambda x, *d: x.permute(*d))((x @ wq).reshape(B, Sq, Hq, Dh), 0, 2, 1, 3)
        k = (lambda x, n, axis: torch.repeat_interleave(x, n, dim=axis))(k_cache, rep, axis=1)
        v = (lambda x, n, axis: torch.repeat_interleave(x, n, dim=axis))(v_cache, rep, axis=1)
        scores = torch.einsum('bhqd,bhkd->bhqk', q, k) * Dh ** (-0.5)
        p = _softmax(scores, axis=-1)
        o = torch.einsum('bhqk,bhkd->bhqd', p, v)
        return (lambda x, *d: x.permute(*d))(o, 0, 2, 1, 3).reshape(B, Sq, Hq * Dh) @ wo

    def _B_ref(x, w_gate, w_up, w_down):
        g = _silu(x @ w_gate)
        u = x @ w_up
        return g * u @ w_down
    x = A_x
    mod = (_silu(c) @ w_mod).reshape(c.shape[0], 6, 1, -1)
    sa, ca, ga, sb, cb, gb = (mod[:, 0].clone(), mod[:, 1].clone(), mod[:, 2].clone(), mod[:, 3].clone(), mod[:, 4].clone(), mod[:, 5].clone())
    h = _layernorm(x, axis=-1) * (1 + ca) + sa
    x = x + ga * _A_ref(h, A_k_cache, A_v_cache, A_wq, A_wo)
    h = _layernorm(x, axis=-1) * (1 + cb) + sb
    x = x + gb * _B_ref(h, B_w_gate, B_w_up, B_w_down)
    return x
```

```asm
; @launch grid=(256,1,1) block=(1024,1,1) lds=163840
.amdgcn_target "amdgcn-amd-amdhsa--gfx950"
.text
.globl adaLN_cond__gqa_block_cached__swiglu_ffn__decode_kernel
.p2align 8
.type adaLN_cond__gqa_block_cached__swiglu_ffn__decode_kernel,@function
adaLN_cond__gqa_block_cached__swiglu_ffn__decode_kernel:
  s_cmp_ge_u32 s2, 256
  s_cbranch_scc1 L_END
  s_load_dwordx16 s[16:31], s[0:1], 0
  s_load_dwordx8 s[32:39], s[0:1], 64
  s_load_dwordx4 s[40:43], s[0:1], 96
  v_lshrrev_b32 v1, 6, v0
  v_and_b32 v0, 63, v0
  v_readfirstlane_b32 s3, v1
  s_and_b32 s4, s2, 7
  s_lshr_b32 s5, s2, 3
  s_add_u32 s78, s5, 16
  s_sub_u32 s79, s5, 4
  s_cmp_lt_u32 s5, 20
  s_cselect_b32 s79, s79, s5
  s_cmp_lt_u32 s5, 4
  s_cselect_b32 s5, s78, s79
  s_lshl_b32 s78, s4, 5
  s_add_u32 s78, s78, s5
  s_lshr_b32 s68, s78, 3
  s_and_b32 s67, s78, 7
  s_lshr_b32 s65, s68, 3
  s_and_b32 s66, s68, 7
  s_lshl_b32 s79, s78, 17
  s_and_b32 s6, s3, 7
  s_mov_b32 s70, 0xffff0000
  s_mov_b32 s71, 0x05040100
  s_mov_b32 s72, 0x07060302
  s_mov_b32 s74, 0x000f000f
  s_mov_b32 s75, 0x000f000f
  s_mov_b32 s76, 0x00f0000f
  s_mov_b32 s77, 0xf0000f00
  v_mov_b32 v2, 1
  v_mov_b32 v3, 131072
  s_lshl_b32 s78, s6, 2
  s_add_u32 s78, s78, 131072
  v_mov_b32 v1, s78
  s_lshl_b32 s9, s6, 14
  s_lshr_b32 s78, s5, 2
  s_cmp_eq_u32 s78, 4
  s_cselect_b32 s73, 1, 0
  s_cselect_b32 s7, 1, 0
  s_cmp_lt_u32 s5, 8
  s_cselect_b32 s7, 1, s7
  s_waitcnt lgkmcnt(0)
  s_mov_b32 s52, s42
  s_mov_b32 s53, s43
  s_mov_b32 s54, 0x400000
  s_mov_b32 s55, 0x20000
  s_load_dword s64, s[42:43], 0
  s_cmp_ge_u32 s3, 8
  s_cbranch_scc1 L_HELPER
  v_lshrrev_b32 v4, 4, v0
  v_and_b32 v5, 15, v0
  v_lshlrev_b32 v6, 8, v4
  v_xor_b32 v7, v5, v4
  v_xor_b32 v8, 0, v7
  v_lshl_add_u32 v8, v8, 4, v6
  v_xor_b32 v9, 4, v7
  v_lshl_add_u32 v9, v9, 4, v6
  v_xor_b32 v10, 8, v7
  v_lshl_add_u32 v10, v10, 4, v6
  v_xor_b32 v11, 12, v7
  v_lshl_add_u32 v11, v11, 4, v6
  v_lshlrev_b32 v12, 4, v0
  s_lshl_b32 s8, s6, 10
  s_add_u32 s44, s18, s79
  s_addc_u32 s45, s19, 0
  s_mov_b32 s46, 0x20000
  s_mov_b32 s47, 0x20000
  s_add_u32 s48, s20, s79
  s_addc_u32 s49, s21, 0
  s_mov_b32 s50, 0x20000
  s_mov_b32 s51, 0x20000
  s_cmp_lt_u32 s5, 8
  s_cbranch_scc1 L_SQ
  s_cmp_eq_u32 s73, 1
  s_cbranch_scc1 L_SM
  s_cmp_ge_u32 s5, 24
  s_cbranch_scc1 L_ST2
  s_sleep 20
  s_add_u32 s10, s8, 0
  s_add_u32 m0, s9, 0
  s_nop 0
  buffer_load_dwordx4 v8, s[44:47], s10 offen nt lds
  s_add_u32 s10, s8, 8192
  s_add_u32 m0, s9, 1024
  s_nop 0
  buffer_load_dwordx4 v9, s[44:47], s10 offen nt lds
  s_add_u32 s10, s8, 16384
  s_add_u32 m0, s9, 2048
  s_nop 0
  buffer_load_dwordx4 v10, s[44:47], s10 offen nt lds
  s_barrier
  s_waitcnt vmcnt(2)
  s_add_u32 s10, s8, 24576
  s_add_u32 m0, s9, 3072
  s_nop 0
  buffer_load_dwordx4 v11, s[44:47], s10 offen nt lds
  s_waitcnt vmcnt(2)
  s_add_u32 s10, s8, 32768
  s_add_u32 m0, s9, 4096
  s_nop 0
  buffer_load_dwordx4 v8, s[44:47], s10 offen nt lds
  s_waitcnt vmcnt(2)
  s_add_u32 s10, s8, 40960
  s_add_u32 m0, s9, 5120
  s_nop 0
  buffer_load_dwordx4 v9, s[44:47], s10 offen nt lds
  s_waitcnt vmcnt(2)
  s_add_u32 s10, s8, 49152
  s_add_u32 m0, s9, 6144
  s_nop 0
  buffer_load_dwordx4 v10, s[44:47], s10 offen nt lds
  s_waitcnt vmcnt(2)
  s_add_u32 s10, s8, 57344
  s_add_u32 m0, s9, 7168
  s_nop 0
  buffer_load_dwordx4 v11, s[44:47], s10 offen nt lds
  s_waitcnt vmcnt(2)
  s_add_u32 s10, s8, 65536
  s_add_u32 m0, s9, 8192
  s_nop 0
  buffer_load_dwordx4 v8, s[44:47], s10 offen nt lds
  s_waitcnt vmcnt(2)
  s_add_u32 s10, s8, 73728
  s_add_u32 m0, s9, 9216
  s_nop 0
  buffer_load_dwordx4 v9, s[44:47], s10 offen nt lds
  s_waitcnt vmcnt(2)
  s_add_u32 s10, s8, 81920
  s_add_u32 m0, s9, 10240
  s_nop 0
  buffer_load_dwordx4 v10, s[44:47], s10 offen nt lds
  s_waitcnt vmcnt(2)
  s_add_u32 s10, s8, 90112
  s_add_u32 m0, s9, 11264
  s_nop 0
  buffer_load_dwordx4 v11, s[44:47], s10 offen nt lds
  s_waitcnt vmcnt(2)
  s_add_u32 s10, s8, 98304
  s_add_u32 m0, s9, 12288
  s_nop 0
  buffer_load_dwordx4 v8, s[44:47], s10 offen nt lds
  s_waitcnt vmcnt(2)
  s_add_u32 s10, s8, 106496
  s_add_u32 m0, s9, 13312
  s_nop 0
  buffer_load_dwordx4 v9, s[44:47], s10 offen nt lds
  s_waitcnt vmcnt(2)
  s_add_u32 s10, s8, 114688
  s_add_u32 m0, s9, 14336
  s_nop 0
  buffer_load_dwordx4 v10, s[44:47], s10 offen nt lds
  s_waitcnt vmcnt(2)
  s_add_u32 s10, s8, 122880
  s_add_u32 m0, s9, 15360
  s_nop 0
  buffer_load_dwordx4 v11, s[44:47], s10 offen nt lds
  s_waitcnt vmcnt(3)
  s_add_u32 s10, s8, 0
  buffer_load_dwordx4 v[64:67], v12, s[48:51], s10 offen nt
  s_waitcnt vmcnt(3)
  s_add_u32 s10, s8, 8192
  buffer_load_dwordx4 v[68:71], v12, s[48:51], s10 offen nt
  s_waitcnt vmcnt(3)
  s_add_u32 s10, s8, 16384
  buffer_load_dwordx4 v[72:75], v12, s[48:51], s10 offen nt
  s_waitcnt vmcnt(3)
  s_waitcnt lgkmcnt(0)
  s_mov_b64 exec, 1
  ds_add_u32 v1, v2 offset:64
  s_mov_b64 exec, -1
  s_add_u32 s10, s8, 24576
  buffer_load_dwordx4 v[76:79], v12, s[48:51], s10 offen nt
  s_waitcnt vmcnt(3)
  s_add_u32 s10, s8, 32768
  buffer_load_dwordx4 v[80:83], v12, s[48:51], s10 offen nt
  s_waitcnt vmcnt(3)
  s_add_u32 s10, s8, 40960
  buffer_load_dwordx4 v[84:87], v12, s[48:51], s10 offen nt
  s_waitcnt vmcnt(3)
  s_add_u32 s10, s8, 49152
  buffer_load_dwordx4 v[88:91], v12, s[48:51], s10 offen nt
  s_waitcnt vmcnt(3)
  s_add_u32 s10, s8, 57344
  buffer_load_dwordx4 v[92:95], v12, s[48:51], s10 offen nt
  s_waitcnt vmcnt(3)
  s_add_u32 s10, s8, 65536
  buffer_load_dwordx4 v[96:99], v12, s[48:51], s10 offen nt
  s_waitcnt vmcnt(3)
  s_add_u32 s10, s8, 73728
  buffer_load_dwordx4 v[100:103], v12, s[48:51], s10 offen nt
  s_waitcnt vmcnt(3)
  s_add_u32 s10, s8, 81920
  buffer_load_dwordx4 v[104:107], v12, s[48:51], s10 offen nt
  s_waitcnt vmcnt(3)
  s_add_u32 s10, s8, 90112
  buffer_load_dwordx4 v[108:111], v12, s[48:51], s10 offen nt
  s_waitcnt vmcnt(3)
  s_add_u32 s10, s8, 98304
  buffer_load_dwordx4 v[112:115], v12, s[48:51], s10 offen nt
  s_waitcnt vmcnt(3)
  s_add_u32 s10, s8, 106496
  buffer_load_dwordx4 v[116:119], v12, s[48:51], s10 offen nt
  s_waitcnt vmcnt(3)
  s_add_u32 s10, s8, 114688
  buffer_load_dwordx4 v[120:123], v12, s[48:51], s10 offen nt
  s_waitcnt vmcnt(3)
  s_add_u32 s10, s8, 122880
  buffer_load_dwordx4 v[124:127], v12, s[48:51], s10 offen nt
  s_branch L_SJ
L_SQ:
  s_barrier
  s_sleep 20
  s_add_u32 s10, s8, 0
  s_add_u32 m0, s9, 0
  s_nop 0
  buffer_load_dwordx4 v8, s[44:47], s10 offen nt lds
  s_add_u32 s10, s8, 8192
  s_add_u32 m0, s9, 1024
  s_nop 0
  buffer_load_dwordx4 v9, s[44:47], s10 offen nt lds
  s_add_u32 s10, s8, 16384
  s_add_u32 m0, s9, 2048
  s_nop 0
  buffer_load_dwordx4 v10, s[44:47], s10 offen nt lds
  s_waitcnt vmcnt(2)
  s_add_u32 s10, s8, 24576
  s_add_u32 m0, s9, 3072
  s_nop 0
  buffer_load_dwordx4 v11, s[44:47], s10 offen nt lds
  s_waitcnt vmcnt(2)
  s_add_u32 s10, s8, 32768
  s_add_u32 m0, s9, 4096
  s_nop 0
  buffer_load_dwordx4 v8, s[44:47], s10 offen nt lds
  s_waitcnt vmcnt(2)
  s_add_u32 s10, s8, 40960
  s_add_u32 m0, s9, 5120
  s_nop 0
  buffer_load_dwordx4 v9, s[44:47], s10 offen nt lds
  s_waitcnt vmcnt(2)
  s_add_u32 s10, s8, 49152
  s_add_u32 m0, s9, 6144
  s_nop 0
  buffer_load_dwordx4 v10, s[44:47], s10 offen nt lds
  s_waitcnt vmcnt(2)
  s_add_u32 s10, s8, 57344
  s_add_u32 m0, s9, 7168
  s_nop 0
  buffer_load_dwordx4 v11, s[44:47], s10 offen nt lds
  s_waitcnt vmcnt(2)
  s_add_u32 s10, s8, 65536
  s_add_u32 m0, s9, 8192
  s_nop 0
  buffer_load_dwordx4 v8, s[44:47], s10 offen nt lds
  s_waitcnt vmcnt(2)
  s_add_u32 s10, s8, 73728
  s_add_u32 m0, s9, 9216
  s_nop 0
  buffer_load_dwordx4 v9, s[44:47], s10 offen nt lds
  s_waitcnt vmcnt(2)
  s_add_u32 s10, s8, 81920
  s_add_u32 m0, s9, 10240
  s_nop 0
  buffer_load_dwordx4 v10, s[44:47], s10 offen nt lds
  s_waitcnt vmcnt(2)
  s_add_u32 s10, s8, 90112
  s_add_u32 m0, s9, 11264
  s_nop 0
  buffer_load_dwordx4 v11, s[44:47], s10 offen nt lds
  s_waitcnt vmcnt(2)
  s_add_u32 s10, s8, 98304
  s_add_u32 m0, s9, 12288
  s_nop 0
  buffer_load_dwordx4 v8, s[44:47], s10 offen nt lds
  s_waitcnt vmcnt(2)
  s_add_u32 s10, s8, 106496
  s_add_u32 m0, s9, 13312
  s_nop 0
  buffer_load_dwordx4 v9, s[44:47], s10 offen nt lds
  s_waitcnt vmcnt(2)
  s_add_u32 s10, s8, 114688
  s_add_u32 m0, s9, 14336
  s_nop 0
  buffer_load_dwordx4 v10, s[44:47], s10 offen nt lds
  s_waitcnt vmcnt(2)
  s_add_u32 s10, s8, 122880
  s_add_u32 m0, s9, 15360
  s_nop 0
  buffer_load_dwordx4 v11, s[44:47], s10 offen nt lds
  s_waitcnt vmcnt(3)
  s_add_u32 s10, s8, 0
  buffer_load_dwordx4 v[64:67], v12, s[48:51], s10 offen nt
  s_waitcnt vmcnt(3)
  s_add_u32 s10, s8, 8192
  buffer_load_dwordx4 v[68:71], v12, s[48:51], s10 offen nt
  s_waitcnt vmcnt(3)
  s_add_u32 s10, s8, 16384
  buffer_load_dwordx4 v[72:75], v12, s[48:51], s10 offen nt
  s_waitcnt vmcnt(3)
  s_waitcnt lgkmcnt(0)
  s_mov_b64 exec, 1
  ds_add_u32 v1, v2 offset:64
  s_mov_b64 exec, -1
  s_add_u32 s10, s8, 24576
  buffer_load_dwordx4 v[76:79], v12, s[48:51], s10 offen nt
  s_waitcnt vmcnt(3)
  s_add_u32 s10, s8, 32768
  buffer_load_dwordx4 v[80:83], v12, s[48:51], s10 offen nt
  s_waitcnt vmcnt(3)
  s_add_u32 s10, s8, 40960
  buffer_load_dwordx4 v[84:87], v12, s[48:51], s10 offen nt
  s_waitcnt vmcnt(3)
  s_add_u32 s10, s8, 49152
  buffer_load_dwordx4 v[88:91], v12, s[48:51], s10 offen nt
  s_waitcnt vmcnt(3)
  s_add_u32 s10, s8, 57344
  buffer_load_dwordx4 v[92:95], v12, s[48:51], s10 offen nt
  s_waitcnt vmcnt(3)
  s_add_u32 s10, s8, 65536
  buffer_load_dwordx4 v[96:99], v12, s[48:51], s10 offen nt
  s_waitcnt vmcnt(3)
  s_add_u32 s10, s8, 73728
  buffer_load_dwordx4 v[100:103], v12, s[48:51], s10 offen nt
  s_waitcnt vmcnt(3)
  s_add_u32 s10, s8, 81920
  buffer_load_dwordx4 v[104:107], v12, s[48:51], s10 offen nt
  s_waitcnt vmcnt(3)
  s_add_u32 s10, s8, 90112
  buffer_load_dwordx4 v[108:111], v12, s[48:51], s10 offen nt
  s_waitcnt vmcnt(3)
  s_add_u32 s10, s8, 98304
  buffer_load_dwordx4 v[112:115], v12, s[48:51], s10 offen nt
  s_waitcnt vmcnt(3)
  s_add_u32 s10, s8, 106496
  buffer_load_dwordx4 v[116:119], v12, s[48:51], s10 offen nt
  s_waitcnt vmcnt(3)
  s_add_u32 s10, s8, 114688
  buffer_load_dwordx4 v[120:123], v12, s[48:51], s10 offen nt
  s_waitcnt vmcnt(3)
  s_add_u32 s10, s8, 122880
  buffer_load_dwordx4 v[124:127], v12, s[48:51], s10 offen nt
  s_branch L_SJ
L_SM:
  s_barrier
  s_sleep 20
  s_add_u32 s10, s8, 0
  s_add_u32 m0, s9, 0
  s_nop 0
  buffer_load_dwordx4 v8, s[44:47], s10 offen nt lds
  s_add_u32 s10, s8, 8192
  s_add_u32 m0, s9, 1024
  s_nop 0
  buffer_load_dwordx4 v9, s[44:47], s10 offen nt lds
  s_add_u32 s10, s8, 16384
  s_add_u32 m0, s9, 2048
  s_nop 0
  buffer_load_dwordx4 v10, s[44:47], s10 offen nt lds
  s_waitcnt vmcnt(2)
  s_add_u32 s10, s8, 24576
  s_add_u32 m0, s9, 3072
  s_nop 0
  buffer_load_dwordx4 v11, s[44:47], s10 offen nt lds
  s_waitcnt vmcnt(2)
  s_add_u32 s10, s8, 32768
  s_add_u32 m0, s9, 4096
  s_nop 0
  buffer_load_dwordx4 v8, s[44:47], s10 offen nt lds
  s_waitcnt vmcnt(2)
  s_add_u32 s10, s8, 40960
  s_add_u32 m0, s9, 5120
  s_nop 0
  buffer_load_dwordx4 v9, s[44:47], s10 offen nt lds
  s_waitcnt vmcnt(2)
  s_add_u32 s10, s8, 49152
  s_add_u32 m0, s9, 6144
  s_nop 0
  buffer_load_dwordx4 v10, s[44:47], s10 offen nt lds
  s_waitcnt vmcnt(2)
  s_add_u32 s10, s8, 57344
  s_add_u32 m0, s9, 7168
  s_nop 0
  buffer_load_dwordx4 v11, s[44:47], s10 offen nt lds
  s_waitcnt vmcnt(2)
  s_add_u32 s10, s8, 65536
  s_add_u32 m0, s9, 8192
  s_nop 0
  buffer_load_dwordx4 v8, s[44:47], s10 offen nt lds
  s_waitcnt vmcnt(2)
  s_add_u32 s10, s8, 73728
  s_add_u32 m0, s9, 9216
  s_nop 0
  buffer_load_dwordx4 v9, s[44:47], s10 offen nt lds
  s_waitcnt vmcnt(2)
  s_add_u32 s10, s8, 81920
  s_add_u32 m0, s9, 10240
  s_nop 0
  buffer_load_dwordx4 v10, s[44:47], s10 offen nt lds
  s_waitcnt vmcnt(2)
  s_add_u32 s10, s8, 90112
  s_add_u32 m0, s9, 11264
  s_nop 0
  buffer_load_dwordx4 v11, s[44:47], s10 offen nt lds
  s_waitcnt vmcnt(2)
  s_add_u32 s10, s8, 98304
  s_add_u32 m0, s9, 12288
  s_nop 0
  buffer_load_dwordx4 v8, s[44:47], s10 offen nt lds
  s_waitcnt vmcnt(2)
  s_add_u32 s10, s8, 106496
  s_add_u32 m0, s9, 13312
  s_nop 0
  buffer_load_dwordx4 v9, s[44:47], s10 offen nt lds
  s_waitcnt vmcnt(2)
  s_add_u32 s10, s8, 114688
  s_add_u32 m0, s9, 14336
  s_nop 0
  buffer_load_dwordx4 v10, s[44:47], s10 offen nt lds
  s_waitcnt vmcnt(2)
  s_add_u32 s10, s8, 122880
  s_add_u32 m0, s9, 15360
  s_nop 0
  buffer_load_dwordx4 v11, s[44:47], s10 offen nt lds
  s_waitcnt vmcnt(3)
  s_add_u32 s10, s8, 0
  buffer_load_dwordx4 v[64:67], v12, s[48:51], s10 offen nt
  s_waitcnt vmcnt(3)
  s_add_u32 s10, s8, 8192
  buffer_load_dwordx4 v[68:71], v12, s[48:51], s10 offen nt
  s_waitcnt vmcnt(3)
  s_add_u32 s10, s8, 16384
  buffer_load_dwordx4 v[72:75], v12, s[48:51], s10 offen nt
  s_waitcnt vmcnt(3)
  s_waitcnt lgkmcnt(0)
  s_mov_b64 exec, 1
  ds_add_u32 v1, v2 offset:64
  s_mov_b64 exec, -1
  s_add_u32 s10, s8, 24576
  buffer_load_dwordx4 v[76:79], v12, s[48:51], s10 offen nt
  s_waitcnt vmcnt(3)
  s_add_u32 s10, s8, 32768
  buffer_load_dwordx4 v[80:83], v12, s[48:51], s10 offen nt
  s_waitcnt vmcnt(3)
  s_add_u32 s10, s8, 40960
  buffer_load_dwordx4 v[84:87], v12, s[48:51], s10 offen nt
  s_waitcnt vmcnt(3)
  s_add_u32 s10, s8, 49152
  buffer_load_dwordx4 v[88:91], v12, s[48:51], s10 offen nt
  s_waitcnt vmcnt(3)
  s_add_u32 s10, s8, 57344
  buffer_load_dwordx4 v[92:95], v12, s[48:51], s10 offen nt
  s_waitcnt vmcnt(3)
  s_add_u32 s10, s8, 65536
  buffer_load_dwordx4 v[96:99], v12, s[48:51], s10 offen nt
  s_waitcnt vmcnt(3)
  s_add_u32 s10, s8, 73728
  buffer_load_dwordx4 v[100:103], v12, s[48:51], s10 offen nt
  s_waitcnt vmcnt(3)
  s_add_u32 s10, s8, 81920
  buffer_load_dwordx4 v[104:107], v12, s[48:51], s10 offen nt
  s_waitcnt vmcnt(3)
  s_add_u32 s10, s8, 90112
  buffer_load_dwordx4 v[108:111], v12, s[48:51], s10 offen nt
  s_waitcnt vmcnt(3)
  s_add_u32 s10, s8, 98304
  buffer_load_dwordx4 v[112:115], v12, s[48:51], s10 offen nt
  s_waitcnt vmcnt(3)
  s_add_u32 s10, s8, 106496
  buffer_load_dwordx4 v[116:119], v12, s[48:51], s10 offen nt
  s_waitcnt vmcnt(3)
  s_add_u32 s10, s8, 114688
  buffer_load_dwordx4 v[120:123], v12, s[48:51], s10 offen nt
  s_waitcnt vmcnt(3)
  s_add_u32 s10, s8, 122880
  buffer_load_dwordx4 v[124:127], v12, s[48:51], s10 offen nt
  s_branch L_SJ
L_ST2:
  s_sleep 20
  s_add_u32 s10, s8, 0
  s_add_u32 m0, s9, 0
  s_nop 0
  buffer_load_dwordx4 v8, s[44:47], s10 offen nt lds
  s_add_u32 s10, s8, 8192
  s_add_u32 m0, s9, 1024
  s_nop 0
  buffer_load_dwordx4 v9, s[44:47], s10 offen nt lds
  s_add_u32 s10, s8, 16384
  s_add_u32 m0, s9, 2048
  s_nop 0
  buffer_load_dwordx4 v10, s[44:47], s10 offen nt lds
  s_barrier
  s_waitcnt vmcnt(2)
  s_add_u32 s10, s8, 24576
  s_add_u32 m0, s9, 3072
  s_nop 0
  buffer_load_dwordx4 v11, s[44:47], s10 offen nt lds
  s_waitcnt vmcnt(2)
  s_add_u32 s10, s8, 32768
  s_add_u32 m0, s9, 4096
  s_nop 0
  buffer_load_dwordx4 v8, s[44:47], s10 offen nt lds
  s_waitcnt vmcnt(2)
  s_add_u32 s10, s8, 40960
  s_add_u32 m0, s9, 5120
  s_nop 0
  buffer_load_dwordx4 v9, s[44:47], s10 offen nt lds
  s_waitcnt vmcnt(2)
  s_add_u32 s10, s8, 49152
  s_add_u32 m0, s9, 6144
  s_nop 0
  buffer_load_dwordx4 v10, s[44:47], s10 offen nt lds
  s_waitcnt vmcnt(2)
  s_add_u32 s10, s8, 57344
  s_add_u32 m0, s9, 7168
  s_nop 0
  buffer_load_dwordx4 v11, s[44:47], s10 offen nt lds
  s_waitcnt vmcnt(2)
  s_add_u32 s10, s8, 65536
  s_add_u32 m0, s9, 8192
  s_nop 0
  buffer_load_dwordx4 v8, s[44:47], s10 offen nt lds
  s_waitcnt vmcnt(2)
  s_add_u32 s10, s8, 73728
  s_add_u32 m0, s9, 9216
  s_nop 0
  buffer_load_dwordx4 v9, s[44:47], s10 offen nt lds
  s_waitcnt vmcnt(2)
  s_add_u32 s10, s8, 81920
  s_add_u32 m0, s9, 10240
  s_nop 0
  buffer_load_dwordx4 v10, s[44:47], s10 offen nt lds
  s_waitcnt vmcnt(2)
  s_add_u32 s10, s8, 90112
  s_add_u32 m0, s9, 11264
  s_nop 0
  buffer_load_dwordx4 v11, s[44:47], s10 offen nt lds
  s_waitcnt vmcnt(2)
  s_add_u32 s10, s8, 98304
  s_add_u32 m0, s9, 12288
  s_nop 0
  buffer_load_dwordx4 v8, s[44:47], s10 offen nt lds
  s_waitcnt vmcnt(2)
  s_add_u32 s10, s8, 106496
  s_add_u32 m0, s9, 13312
  s_nop 0
  buffer_load_dwordx4 v9, s[44:47], s10 offen nt lds
  s_waitcnt vmcnt(2)
  s_add_u32 s10, s8, 114688
  s_add_u32 m0, s9, 14336
  s_nop 0
  buffer_load_dwordx4 v10, s[44:47], s10 offen nt lds
  s_waitcnt vmcnt(2)
  s_add_u32 s10, s8, 122880
  s_add_u32 m0, s9, 15360
  s_nop 0
  buffer_load_dwordx4 v11, s[44:47], s10 offen nt lds
  s_waitcnt vmcnt(3)
  s_add_u32 s10, s8, 0
  buffer_load_dwordx4 v[64:67], v12, s[48:51], s10 offen nt
  s_waitcnt vmcnt(3)
  s_add_u32 s10, s8, 8192
  buffer_load_dwordx4 v[68:71], v12, s[48:51], s10 offen nt
  s_waitcnt vmcnt(3)
  s_add_u32 s10, s8, 16384
  buffer_load_dwordx4 v[72:75], v12, s[48:51], s10 offen nt
  s_waitcnt vmcnt(3)
  s_waitcnt lgkmcnt(0)
  s_mov_b64 exec, 1
  ds_add_u32 v1, v2 offset:64
  s_mov_b64 exec, -1
  s_add_u32 s10, s8, 24576
  buffer_load_dwordx4 v[76:79], v12, s[48:51], s10 offen nt
  s_waitcnt vmcnt(3)
  s_add_u32 s10, s8, 32768
  buffer_load_dwordx4 v[80:83], v12, s[48:51], s10 offen nt
  s_waitcnt vmcnt(3)
  s_add_u32 s10, s8, 40960
  buffer_load_dwordx4 v[84:87], v12, s[48:51], s10 offen nt
  s_waitcnt vmcnt(3)
  s_add_u32 s10, s8, 49152
  buffer_load_dwordx4 v[88:91], v12, s[48:51], s10 offen nt
  s_waitcnt vmcnt(3)
  s_add_u32 s10, s8, 57344
  buffer_load_dwordx4 v[92:95], v12, s[48:51], s10 offen nt
  s_waitcnt vmcnt(3)
  s_add_u32 s10, s8, 65536
  buffer_load_dwordx4 v[96:99], v12, s[48:51], s10 offen nt
  s_waitcnt vmcnt(3)
  s_add_u32 s10, s8, 73728
  buffer_load_dwordx4 v[100:103], v12, s[48:51], s10 offen nt
  s_waitcnt vmcnt(3)
  s_add_u32 s10, s8, 81920
  buffer_load_dwordx4 v[104:107], v12, s[48:51], s10 offen nt
  s_waitcnt vmcnt(3)
  s_add_u32 s10, s8, 90112
  buffer_load_dwordx4 v[108:111], v12, s[48:51], s10 offen nt
  s_waitcnt vmcnt(3)
  s_add_u32 s10, s8, 98304
  buffer_load_dwordx4 v[112:115], v12, s[48:51], s10 offen nt
  s_waitcnt vmcnt(3)
  s_add_u32 s10, s8, 106496
  buffer_load_dwordx4 v[116:119], v12, s[48:51], s10 offen nt
  s_waitcnt vmcnt(3)
  s_add_u32 s10, s8, 114688
  buffer_load_dwordx4 v[120:123], v12, s[48:51], s10 offen nt
  s_waitcnt vmcnt(3)
  s_add_u32 s10, s8, 122880
  buffer_load_dwordx4 v[124:127], v12, s[48:51], s10 offen nt
L_SJ:
  s_waitcnt lgkmcnt(0)
  s_mov_b64 exec, 1
  ds_add_u32 v1, v2 offset:128
  s_mov_b64 exec, -1
  v_and_b32 v5, 3, v0
  v_lshlrev_b32 v6, 2, v4
  v_add_u32 v6, v6, v5
  v_lshlrev_b32 v6, 4, v6
  s_lshl_b32 s10, s6, 9
  s_add_u32 s10, s10, 133120
  v_add_u32 v6, s10, v6
  v_lshlrev_b32 v7, 4, v0
  s_lshl_b32 s10, s6, 4
  s_add_u32 s10, s10, s9
  v_add_u32 v7, s10, v7
  v_and_b32 v10, 3, v0
  v_mul_u32_u24 v10, 16400, v10
  v_bfe_u32 v11, v0, 2, 3
  v_lshl_add_u32 v10, v11, 8, v10
  v_lshrrev_b32 v11, 5, v0
  v_lshl_add_u32 v10, v11, 4, v10
  s_lshl_b32 s10, s6, 5
  s_add_u32 s10, s10, 8192
  v_add_u32 v10, s10, v10
  v_add_u32 v11, 65600, v10
  v_lshrrev_b32 v13, 2, v0
  v_lshlrev_b32 v13, 4, v13
  s_lshl_b32 s12, s66, 2
  s_add_u32 s12, s12, s65
  s_lshl_b32 s12, s12, 3
  s_add_u32 s12, s12, s67
  s_lshl_b32 s12, s12, 11
  s_lshl_b32 s11, s6, 8
  s_add_u32 s12, s12, s11
  s_add_u32 s12, s12, 262144
  s_waitcnt lgkmcnt(0)
  s_mul_i32 s78, s64, 0x9E3779B1
  s_add_u32 s78, s78, 0x7F4A7C15
  s_and_b32 s60, s78, 0xff
  s_bfe_u32 s61, s78, 0x80008
  s_bfe_u32 s62, s78, 0x80010
  s_lshr_b32 s63, s78, 24
  s_mov_b32 s0, s78
  s_mov_b32 s1, 0xffffff00
  s_mov_b32 s26, 0x0c0c0400
  s_mov_b32 s27, 0x04000c0c
  s_waitcnt vmcnt(8)
  v_perm_b32 v32, v68, v64, s71
  v_perm_b32 v36, v68, v64, s72
  v_perm_b32 v33, v76, v72, s71
  v_perm_b32 v37, v76, v72, s72
  v_perm_b32 v34, v84, v80, s71
  v_perm_b32 v38, v84, v80, s72
  v_perm_b32 v35, v92, v88, s71
  v_perm_b32 v39, v92, v88, s72
  v_perm_b32 v40, v69, v65, s71
  v_perm_b32 v44, v69, v65, s72
  v_perm_b32 v41, v77, v73, s71
  v_perm_b32 v45, v77, v73, s72
  v_perm_b32 v42, v85, v81, s71
  v_perm_b32 v46, v85, v81, s72
  v_perm_b32 v43, v93, v89, s71
  v_perm_b32 v47, v93, v89, s72
  v_perm_b32 v48, v70, v66, s71
  v_perm_b32 v52, v70, v66, s72
  v_perm_b32 v49, v78, v74, s71
  v_perm_b32 v53, v78, v74, s72
  v_perm_b32 v50, v86, v82, s71
  v_perm_b32 v54, v86, v82, s72
  v_perm_b32 v51, v94, v90, s71
  v_perm_b32 v55, v94, v90, s72
  v_perm_b32 v56, v71, v67, s71
  v_perm_b32 v60, v71, v67, s72
  v_perm_b32 v57, v79, v75, s71
  v_perm_b32 v61, v79, v75, s72
  v_perm_b32 v58, v87, v83, s71
  v_perm_b32 v62, v87, v83, s72
  v_perm_b32 v59, v95, v91, s71
  v_perm_b32 v63, v95, v91, s72
  s_waitcnt vmcnt(0)
  v_perm_b32 v64, v100, v96, s71
  v_perm_b32 v68, v100, v96, s72
  v_perm_b32 v65, v108, v104, s71
  v_perm_b32 v69, v108, v104, s72
  v_perm_b32 v66, v116, v112, s71
  v_perm_b32 v70, v116, v112, s72
  v_perm_b32 v67, v124, v120, s71
  v_perm_b32 v71, v124, v120, s72
  v_perm_b32 v72, v101, v97, s71
  v_perm_b32 v76, v101, v97, s72
  v_perm_b32 v73, v109, v105, s71
  v_perm_b32 v77, v109, v105, s72
  v_perm_b32 v74, v117, v113, s71
  v_perm_b32 v78, v117, v113, s72
  v_perm_b32 v75, v125, v121, s71
  v_perm_b32 v79, v125, v121, s72
  v_perm_b32 v80, v102, v98, s71
  v_perm_b32 v84, v102, v98, s72
  v_perm_b32 v81, v110, v106, s71
  v_perm_b32 v85, v110, v106, s72
  v_perm_b32 v82, v118, v114, s71
  v_perm_b32 v86, v118, v114, s72
  v_perm_b32 v83, v126, v122, s71
  v_perm_b32 v87, v126, v122, s72
  v_perm_b32 v88, v103, v99, s71
  v_perm_b32 v92, v103, v99, s72
  v_perm_b32 v89, v111, v107, s71
  v_perm_b32 v93, v111, v107, s72
  v_perm_b32 v90, v119, v115, s71
  v_perm_b32 v94, v119, v115, s72
  v_perm_b32 v91, v127, v123, s71
  v_perm_b32 v95, v127, v123, s72
  s_mov_b32 s69, 400000
W_1:
  ds_read_b32 v15, v1 offset:96
  s_waitcnt lgkmcnt(0)
  v_cmp_gt_u32 vcc, 1, v15
  s_nop 0
  s_cbranch_vccz WD_2
  s_sleep 1
  s_sub_u32 s69, s69, 1
  s_cbranch_scc0 W_1
WD_2:
  ds_read_b128 v[16:19], v6
  ds_read_b128 v[20:23], v6 offset:256
  s_waitcnt lgkmcnt(1)
  v_mfma_f32_16x16x32_bf16 v[96:99], v[16:19], v[32:35], 0
  v_mfma_f32_16x16x32_bf16 v[100:103], v[16:19], v[36:39], 0
  v_mfma_f32_16x16x32_bf16 v[104:107], v[16:19], v[40:43], 0
  v_mfma_f32_16x16x32_bf16 v[108:111], v[16:19], v[44:47], 0
  v_mfma_f32_16x16x32_bf16 v[112:115], v[16:19], v[48:51], 0
  v_mfma_f32_16x16x32_bf16 v[116:119], v[16:19], v[52:55], 0
  v_mfma_f32_16x16x32_bf16 v[120:123], v[16:19], v[56:59], 0
  v_mfma_f32_16x16x32_bf16 v[124:127], v[16:19], v[60:63], 0
  s_waitcnt lgkmcnt(0)
  v_mfma_f32_16x16x32_bf16 v[96:99], v[20:23], v[64:67], v[96:99]
  v_mfma_f32_16x16x32_bf16 v[100:103], v[20:23], v[68:71], v[100:103]
  v_mfma_f32_16x16x32_bf16 v[104:107], v[20:23], v[72:75], v[104:107]
  v_mfma_f32_16x16x32_bf16 v[108:111], v[20:23], v[76:79], v[108:111]
  v_mfma_f32_16x16x32_bf16 v[112:115], v[20:23], v[80:83], v[112:115]
  v_mfma_f32_16x16x32_bf16 v[116:119], v[20:23], v[84:87], v[116:119]
  v_mfma_f32_16x16x32_bf16 v[120:123], v[20:23], v[88:91], v[120:123]
  v_mfma_f32_16x16x32_bf16 v[124:127], v[20:23], v[92:95], v[124:127]
  s_mov_b32 exec_lo, 0xffff
  s_mov_b32 exec_hi, 0x0
  ds_write_b128 v7, v[96:99] offset:8192
  ds_write_b128 v7, v[100:103] offset:8448
  ds_write_b128 v7, v[104:107] offset:8704
  ds_write_b128 v7, v[108:111] offset:8960
  ds_write_b128 v7, v[112:115] offset:9216
  ds_write_b128 v7, v[116:119] offset:9472
  ds_write_b128 v7, v[120:123] offset:9728
  ds_write_b128 v7, v[124:127] offset:9984
  s_mov_b64 exec, -1
  s_waitcnt lgkmcnt(0)
  s_mov_b64 exec, 1
  ds_add_u32 v3, v2 offset:24
  s_mov_b64 exec, -1
  s_mov_b32 s69, 400000
W_3:
  ds_read_b32 v15, v3 offset:24
  s_waitcnt lgkmcnt(0)
  v_cmp_gt_u32 vcc, 8, v15
  s_nop 0
  s_cbranch_vccz WD_4
  s_sub_u32 s69, s69, 1
  s_cbranch_scc0 W_3
WD_4:
  ds_read_b128 v[16:19], v10
  ds_read_b128 v[20:23], v11
  s_waitcnt lgkmcnt(0)
  v_pk_add_f32 v[16:17], v[16:17], v[20:21]
  v_pk_add_f32 v[18:19], v[18:19], v[22:23]
  s_nop 0
  v_add_f32_dpp v16, v16, v16 quad_perm:[1,0,3,2] row_mask:0xf bank_mask:0xf
  v_add_f32_dpp v17, v17, v17 quad_perm:[1,0,3,2] row_mask:0xf bank_mask:0xf
  v_add_f32_dpp v18, v18, v18 quad_perm:[1,0,3,2] row_mask:0xf bank_mask:0xf
  v_add_f32_dpp v19, v19, v19 quad_perm:[1,0,3,2] row_mask:0xf bank_mask:0xf
  v_add_f32_dpp v16, v16, v16 quad_perm:[2,3,0,1] row_mask:0xf bank_mask:0xf
  v_add_f32_dpp v17, v17, v17 quad_perm:[2,3,0,1] row_mask:0xf bank_mask:0xf
  v_add_f32_dpp v18, v18, v18 quad_perm:[2,3,0,1] row_mask:0xf bank_mask:0xf
  v_add_f32_dpp v19, v19, v19 quad_perm:[2,3,0,1] row_mask:0xf bank_mask:0xf
  v_add_u32 v16, 0x80, v16
  v_add_u32 v17, 0x80, v17
  v_add_u32 v18, 0x80, v18
  v_add_u32 v19, 0x80, v19
  v_and_b32 v16, 0xffffff00, v16
  v_and_b32 v17, 0xffffff00, v17
  v_and_b32 v18, 0xffffff00, v18
  v_and_b32 v19, 0xffffff00, v19
  v_or_b32 v16, s60, v16
  v_or_b32 v17, s61, v17
  v_or_b32 v18, s62, v18
  v_or_b32 v19, s63, v19
  s_mov_b32 exec_lo, 0x11111111
  s_mov_b32 exec_hi, 0x11111111
  buffer_store_dwordx4 v[16:19], v13, s[52:55], s12 offen sc1
  s_mov_b64 exec, -1
  s_branch L_TAIL
L_HELPER:
  v_lshrrev_b32 v5, 4, v0
  v_and_b32 v6, 15, v0
  s_and_b32 s14, s6, 3
  s_lshr_b32 s15, s6, 2
  s_cmp_lt_u32 s5, 8
  s_cbranch_scc1 L_HQR
  s_cmp_eq_u32 s73, 1
  s_cbranch_scc1 L_HM
  s_sub_u32 s10, s5, 20
  s_cmp_lt_u32 s10, 4
  s_cbranch_scc1 L_HLM
  s_cmp_ge_u32 s5, 15
  s_cbranch_scc1 NOX_5
  s_cmp_ge_u32 s6, 4
  s_cbranch_scc1 XL_6
  s_mov_b32 s56, s16
  s_mov_b32 s57, s17
  s_mov_b32 s58, 0x1000
  s_mov_b32 s59, 0x20000
  s_lshl_b32 s10, s6, 10
  v_lshlrev_b32 v10, 4, v0
  buffer_load_dwordx4 v[28:31], v10, s[56:59], s10 offen
XL_6:
  s_cmp_ge_u32 s6, 4
  s_cbranch_scc1 XS_7
  v_lshrrev_b32 v10, 2, v0
  v_lshlrev_b32 v10, 6, v10
  v_and_b32 v11, 3, v0
  v_lshl_add_u32 v10, v11, 1, v10
  s_lshl_b32 s10, s6, 10
  s_add_u32 s10, s10, 153600
  v_add_u32 v10, s10, v10
  s_waitcnt vmcnt(0)
  ds_write_b16 v10, v28 offset:0
  ds_write_b16_d16_hi v10, v28 offset:8
  ds_write_b16 v10, v29 offset:16
  ds_write_b16_d16_hi v10, v29 offset:24
  ds_write_b16 v10, v30 offset:32
  ds_write_b16_d16_hi v10, v30 offset:40
  ds_write_b16 v10, v31 offset:48
  ds_write_b16_d16_hi v10, v31 offset:56
XS_7:
NOX_5:
  s_cmp_lg_u32 s6, 0
  s_cbranch_scc1 NZ_8
  v_lshlrev_b32 v10, 2, v0
  v_mov_b32 v11, 0
  v_add_u32 v10, 131072, v10
  ds_write_b32 v10, v11
  s_waitcnt lgkmcnt(0)
NZ_8:
  s_barrier
  s_waitcnt lgkmcnt(0)
  s_mul_i32 s78, s64, 0x9E3779B1
  s_add_u32 s78, s78, 0x7F4A7C15
  s_and_b32 s60, s78, 0xff
  s_bfe_u32 s61, s78, 0x80008
  s_bfe_u32 s62, s78, 0x80010
  s_lshr_b32 s63, s78, 24
  s_mov_b32 s0, s78
  s_mov_b32 s1, 0xffffff00
  s_mov_b32 s26, 0x0c0c0400
  s_mov_b32 s27, 0x04000c0c
  s_cmp_lt_u32 s5, 24
  s_cbranch_scc1 T2E_9
  s_mov_b32 s44, s24
  s_mov_b32 s45, s25
  s_mov_b32 s46, 0x400000
  s_mov_b32 s47, 0x20000
  v_lshrrev_b32 v10, 3, v0
  v_lshlrev_b32 v10, 11, v10
  v_and_b32 v11, 7, v0
  v_lshl_add_u32 v10, v11, 4, v10
  s_lshl_b32 s10, s4, 9
  s_lshl_b32 s11, s6, 4
  s_add_u32 s10, s10, s11
  s_lshl_b32 s10, s10, 10
  s_sub_u32 s11, s5, 24
  s_lshl_b32 s11, s11, 7
  s_add_u32 s10, s10, s11
  s_and_b32 s12, s6, 6
  s_cmp_lg_u32 s12, 2
  s_cbranch_scc1 TP_10
  s_waitcnt vmcnt(3)
  buffer_load_dwordx4 v[64:67], v10, s[44:47], s10 offen nt
  s_waitcnt vmcnt(3)
  s_add_u32 s11, s10, 131072
  buffer_load_dwordx4 v[68:71], v10, s[44:47], s11 offen nt
  s_waitcnt vmcnt(3)
  s_add_u32 s11, s10, 262144
  buffer_load_dwordx4 v[72:75], v10, s[44:47], s11 offen nt
  s_waitcnt vmcnt(3)
  s_add_u32 s11, s10, 393216
  buffer_load_dwordx4 v[76:79], v10, s[44:47], s11 offen nt
  s_waitcnt vmcnt(3)
  s_add_u32 s11, s10, 1024
  buffer_load_dwordx4 v[80:83], v10, s[44:47], s11 offen nt
  s_waitcnt vmcnt(3)
  s_add_u32 s11, s10, 132096
  buffer_load_dwordx4 v[84:87], v10, s[44:47], s11 offen nt
  s_waitcnt vmcnt(3)
  s_add_u32 s11, s10, 263168
  buffer_load_dwordx4 v[88:91], v10, s[44:47], s11 offen nt
  s_waitcnt vmcnt(3)
  s_add_u32 s11, s10, 394240
  buffer_load_dwordx4 v[92:95], v10, s[44:47], s11 offen nt
  s_branch TP_11
TP_10:
  s_waitcnt vmcnt(1)
  buffer_load_dwordx4 v[64:67], v10, s[44:47], s10 offen nt
  s_waitcnt vmcnt(1)
  s_add_u32 s11, s10, 131072
  buffer_load_dwordx4 v[68:71], v10, s[44:47], s11 offen nt
  s_waitcnt vmcnt(1)
  s_add_u32 s11, s10, 262144
  buffer_load_dwordx4 v[72:75], v10, s[44:47], s11 offen nt
  s_waitcnt vmcnt(1)
  s_add_u32 s11, s10, 393216
  buffer_load_dwordx4 v[76:79], v10, s[44:47], s11 offen nt
  s_waitcnt vmcnt(1)
  s_add_u32 s11, s10, 1024
  buffer_load_dwordx4 v[80:83], v10, s[44:47], s11 offen nt
  s_waitcnt vmcnt(1)
  s_add_u32 s11, s10, 132096
  buffer_load_dwordx4 v[84:87], v10, s[44:47], s11 offen nt
  s_waitcnt vmcnt(1)
  s_add_u32 s11, s10, 263168
  buffer_load_dwordx4 v[88:91], v10, s[44:47], s11 offen nt
  s_waitcnt vmcnt(1)
  s_add_u32 s11, s10, 394240
  buffer_load_dwordx4 v[92:95], v10, s[44:47], s11 offen nt
TP_11:
  s_branch L_HC1
T2E_9:
  s_branch L_HC1
L_HM:
  s_lshl_b32 s13, s4, 2
  s_add_u32 s13, s13, s5
  s_sub_u32 s13, s13, 16
  s_mov_b32 s56, s34
  s_mov_b32 s57, s35
  s_mov_b32 s58, 0x1000
  s_mov_b32 s59, 0x20000
  s_lshl_b32 s10, s6, 9
  v_lshlrev_b32 v10, 3, v0
  buffer_load_dwordx2 v[12:13], v10, s[56:59], s10 offen
  s_cmp_ge_u32 s6, 4
  s_cbranch_scc1 M1_12
  s_mov_b32 s44, s36
  s_mov_b32 s45, s37
  s_mov_b32 s46, 0x300000
  s_mov_b32 s47, 0x20000
  v_lshrrev_b32 v10, 2, v0
  v_mul_u32_u24 v10, 49152, v10
  v_and_b32 v11, 3, v0
  v_lshl_add_u32 v10, v11, 4, v10
  s_mul_i32 s10, s14, 786432
  s_lshl_b32 s11, s13, 6
  s_add_u32 s10, s10, s11
  buffer_load_dwordx4 v[96:99], v10, s[44:47], s10 offen nt
  s_add_u32 s11, s10, 6144
  buffer_load_dwordx4 v[100:103], v10, s[44:47], s11 offen nt
  s_add_u32 s11, s10, 12288
  buffer_load_dwordx4 v[104:107], v10, s[44:47], s11 offen nt
  s_add_u32 s11, s10, 18432
  buffer_load_dwordx4 v[108:111], v10, s[44:47], s11 offen nt
  s_add_u32 s11, s10, 24576
  buffer_load_dwordx4 v[112:115], v10, s[44:47], s11 offen nt
  s_add_u32 s11, s10, 30720
  buffer_load_dwordx4 v[116:119], v10, s[44:47], s11 offen nt
  s_add_u32 s11, s10, 36864
  buffer_load_dwordx4 v[120:123], v10, s[44:47], s11 offen nt
  s_add_u32 s11, s10, 43008
  buffer_load_dwordx4 v[124:127], v10, s[44:47], s11 offen nt
M1_12:
  s_cmp_lg_u32 s6, 0
  s_cbranch_scc1 NZ_13
  v_lshlrev_b32 v10, 2, v0
  v_mov_b32 v11, 0
  v_add_u32 v10, 131072, v10
  ds_write_b32 v10, v11
  s_waitcnt lgkmcnt(0)
NZ_13:
  s_barrier
  s_waitcnt lgkmcnt(0)
  s_mul_i32 s78, s64, 0x9E3779B1
  s_add_u32 s78, s78, 0x7F4A7C15
  s_and_b32 s60, s78, 0xff
  s_bfe_u32 s61, s78, 0x80008
  s_bfe_u32 s62, s78, 0x80010
  s_lshr_b32 s63, s78, 24
  s_mov_b32 s0, s78
  s_mov_b32 s1, 0xffffff00
  s_mov_b32 s26, 0x0c0c0400
  s_mov_b32 s27, 0x04000c0c
  s_cmp_ge_u32 s6, 4
  s_cbranch_scc1 M2_14
  s_waitcnt vmcnt(8)
  v_lshlrev_b32 v16, 16, v12
  v_and_b32 v17, s70, v12
  v_lshlrev_b32 v18, 16, v13
  v_and_b32 v19, s70, v13
  v_mul_f32 v20, 0xbfb8aa3b, v16
  v_mul_f32 v21, 0xbfb8aa3b, v17
  v_mul_f32 v22, 0xbfb8aa3b, v18
  v_mul_f32 v23, 0xbfb8aa3b, v19
  v_exp_f32 v20, v20
  v_exp_f32 v21, v21
  v_exp_f32 v22, v22
  v_exp_f32 v23, v23
  v_add_f32 v20, 1.0, v20
  v_add_f32 v21, 1.0, v21
  v_add_f32 v22, 1.0, v22
  v_add_f32 v23, 1.0, v23
  v_rcp_f32 v20, v20
  v_rcp_f32 v21, v21
  v_rcp_f32 v22, v22
  v_rcp_f32 v23, v23
  v_mul_f32 v16, v16, v20
  v_mul_f32 v17, v17, v21
  v_mul_f32 v18, v18, v22
  v_mul_f32 v19, v19, v23
  v_cvt_pk_bf16_f32 v12, v16, v17
  v_cvt_pk_bf16_f32 v13, v18, v19
  v_lshlrev_b32 v10, 3, v0
  s_lshl_b32 s10, s6, 9
  s_add_u32 s10, s10, 137216
  v_add_u32 v10, s10, v10
  ds_write_b64 v10, v[12:13]
  s_waitcnt lgkmcnt(0)
  s_mov_b64 exec, 1
  ds_add_u32 v3, v2 offset:0
  s_mov_b64 exec, -1
  v_and_b32 v10, 3, v0
  v_lshlrev_b32 v11, 10, v10
  v_lshrrev_b32 v12, 2, v0
  v_lshl_add_u32 v11, v12, 4, v11
  s_lshl_b32 s10, s14, 8
  s_add_u32 s10, s10, 137216
  v_add_u32 v11, s10, v11
  v_lshlrev_b32 v12, 4, v10
  v_mul_u32_u24 v13, 528, v5
  v_add_u32 v12, v12, v13
  s_mul_i32 s10, s6, 2112
  s_add_u32 s10, s10, 141312
  v_add_u32 v12, s10, v12
  v_and_b32 v13, 7, v0
  v_mul_u32_u24 v13, 528, v13
  v_lshrrev_b32 v14, 3, v0
  v_lshl_add_u32 v13, v14, 6, v13
  s_lshl_b32 s10, s14, 4
  s_mul_i32 s11, s15, 8448
  s_add_u32 s10, s10, s11
  s_add_u32 s10, s10, 141312
  v_add_u32 v13, s10, v13
  v_lshlrev_b32 v14, 4, v14
  s_mul_i32 s10, s14, 12288
  s_lshl_b32 s11, s13, 7
  s_add_u32 s10, s10, s11
  s_add_u32 s12, s10, 65536
  s_lshl_b32 s10, s15, 2
  s_add_u32 s10, s10, 131072
  v_mov_b32 v9, s10
  s_mov_b32 s69, 400000
W_15:
  ds_read_b32 v4, v3 offset:0
  s_waitcnt lgkmcnt(0)
  v_cmp_gt_u32 vcc, 8, v4
  s_nop 0
  s_cbranch_vccz WD_16
  s_sub_u32 s69, s69, 1
  s_cbranch_scc0 W_15
WD_16:
  ds_read_b128 v[24:27], v11
  s_waitcnt vmcnt(0) lgkmcnt(0)
  v_perm_b32 v16, v100, v96, s71
  v_perm_b32 v17, v108, v104, s71
  v_perm_b32 v18, v116, v112, s71
  v_perm_b32 v19, v124, v120, s71
  v_perm_b32 v20, v100, v96, s72
  v_perm_b32 v21, v108, v104, s72
  v_perm_b32 v22, v116, v112, s72
  v_perm_b32 v23, v124, v120, s72
  v_mfma_f32_16x16x32_bf16 v[32:35], v[16:19], v[24:27], 0
  s_nop 0
  v_mfma_f32_16x16x32_bf16 v[36:39], v[20:23], v[24:27], 0
  v_perm_b32 v16, v101, v97, s71
  v_perm_b32 v17, v109, v105, s71
  v_perm_b32 v18, v117, v113, s71
  v_perm_b32 v19, v125, v121, s71
  v_perm_b32 v20, v101, v97, s72
  v_perm_b32 v21, v109, v105, s72
  v_perm_b32 v22, v117, v113, s72
  v_perm_b32 v23, v125, v121, s72
  v_mfma_f32_16x16x32_bf16 v[40:43], v[16:19], v[24:27], 0
  s_nop 0
  v_mfma_f32_16x16x32_bf16 v[44:47], v[20:23], v[24:27], 0
  v_perm_b32 v16, v102, v98, s71
  v_perm_b32 v17, v110, v106, s71
  v_perm_b32 v18, v118, v114, s71
  v_perm_b32 v19, v126, v122, s71
  v_perm_b32 v20, v102, v98, s72
  v_perm_b32 v21, v110, v106, s72
  v_perm_b32 v22, v118, v114, s72
  v_perm_b32 v23, v126, v122, s72
  v_mfma_f32_16x16x32_bf16 v[48:51], v[16:19], v[24:27], 0
  s_nop 0
  v_mfma_f32_16x16x32_bf16 v[52:55], v[20:23], v[24:27], 0
  v_perm_b32 v16, v103, v99, s71
  v_perm_b32 v17, v111, v107, s71
  v_perm_b32 v18, v119, v115, s71
  v_perm_b32 v19, v127, v123, s71
  v_perm_b32 v20, v103, v99, s72
  v_perm_b32 v21, v111, v107, s72
  v_perm_b32 v22, v119, v115, s72
  v_perm_b32 v23, v127, v123, s72
  v_mfma_f32_16x16x32_bf16 v[56:59], v[16:19], v[24:27], 0
  s_nop 0
  v_mfma_f32_16x16x32_bf16 v[60:63], v[20:23], v[24:27], 0
  s_mov_b64 exec, s[76:77]
  ds_write_b128 v12, v[32:35] offset:0
  ds_write_b128 v12, v[36:39] offset:64
  ds_write_b128 v12, v[40:43] offset:128
  ds_write_b128 v12, v[44:47] offset:192
  ds_write_b128 v12, v[48:51] offset:256
  ds_write_b128 v12, v[52:55] offset:320
  ds_write_b128 v12, v[56:59] offset:384
  ds_write_b128 v12, v[60:63] offset:448
  s_mov_b64 exec, -1
  s_waitcnt lgkmcnt(0)
  s_mov_b64 exec, 1
  ds_add_u32 v9, v2 offset:4
  s_mov_b64 exec, -1
  s_mov_b32 s69, 400000
W_17:
  ds_read_b32 v4, v9 offset:4
  s_waitcnt lgkmcnt(0)
  v_cmp_gt_u32 vcc, 4, v4
  s_nop 0
  s_cbranch_vccz WD_18
  s_sub_u32 s69, s69, 1
  s_cbranch_scc0 W_17
WD_18:
  ds_read_b128 v[16:19], v13 offset:0
  ds_read_b128 v[20:23], v13 offset:4224
  s_waitcnt lgkmcnt(0)
  v_pk_add_f32 v[16:17], v[16:17], v[20:21]
  v_pk_add_f32 v[18:19], v[18:19], v[22:23]
  s_nop 0
  v_add_f32_dpp v16, v16, v16 quad_perm:[1,0,3,2] row_mask:0xf bank_mask:0xf
  v_add_f32_dpp v17, v17, v17 quad_perm:[1,0,3,2] row_mask:0xf bank_mask:0xf
  v_add_f32_dpp v18, v18, v18 quad_perm:[1,0,3,2] row_mask:0xf bank_mask:0xf
  v_add_f32_dpp v19, v19, v19 quad_perm:[1,0,3,2] row_mask:0xf bank_mask:0xf
  v_add_f32_dpp v16, v16, v16 quad_perm:[2,3,0,1] row_mask:0xf bank_mask:0xf
  v_add_f32_dpp v17, v17, v17 quad_perm:[2,3,0,1] row_mask:0xf bank_mask:0xf
  v_add_f32_dpp v18, v18, v18 quad_perm:[2,3,0,1] row_mask:0xf bank_mask:0xf
  v_add_f32_dpp v19, v19, v19 quad_perm:[2,3,0,1] row_mask:0xf bank_mask:0xf
  v_add_f32_dpp v16, v16, v16 row_half_mirror row_mask:0xf bank_mask:0xf
  v_add_f32_dpp v17, v17, v17 row_half_mirror row_mask:0xf bank_mask:0xf
  v_add_f32_dpp v18, v18, v18 row_half_mirror row_mask:0xf bank_mask:0xf
  v_add_f32_dpp v19, v19, v19 row_half_mirror row_mask:0xf bank_mask:0xf
  v_cvt_pk_bf16_f32 v20, v16, v17
  v_cvt_pk_bf16_f32 v21, v18, v19
  v_lshl_or_b32 v16, v20, 16, s60
  v_and_b32 v17, s70, v20
  v_lshl_or_b32 v18, v21, 16, s62
  v_and_b32 v19, s70, v21
  v_or_b32 v17, s61, v17
  v_or_b32 v19, s63, v19
  s_mov_b32 exec_lo, 0x1010101
  s_mov_b32 exec_hi, 0x1010101
  buffer_store_dwordx4 v[16:19], v14, s[52:55], s12 offen sc1
  s_mov_b64 exec, -1
  s_branch L_HC1
M2_14:
  s_waitcnt vmcnt(0)
  v_lshlrev_b32 v16, 16, v12
  v_and_b32 v17, s70, v12
  v_lshlrev_b32 v18, 16, v13
  v_and_b32 v19, s70, v13
  v_mul_f32 v20, 0xbfb8aa3b, v16
  v_mul_f32 v21, 0xbfb8aa3b, v17
  v_mul_f32 v22, 0xbfb8aa3b, v18
  v_mul_f32 v23, 0xbfb8aa3b, v19
  v_exp_f32 v20, v20
  v_exp_f32 v21, v21
  v_exp_f32 v22, v22
  v_exp_f32 v23, v23
  v_add_f32 v20, 1.0, v20
  v_add_f32 v21, 1.0, v21
  v_add_f32 v22, 1.0, v22
  v_add_f32 v23, 1.0, v23
  v_rcp_f32 v20, v20
  v_rcp_f32 v21, v21
  v_rcp_f32 v22, v22
  v_rcp_f32 v23, v23
  v_mul_f32 v16, v16, v20
  v_mul_f32 v17, v17, v21
  v_mul_f32 v18, v18, v22
  v_mul_f32 v19, v19, v23
  v_cvt_pk_bf16_f32 v12, v16, v17
  v_cvt_pk_bf16_f32 v13, v18, v19
  v_lshlrev_b32 v10, 3, v0
  s_lshl_b32 s10, s6, 9
  s_add_u32 s10, s10, 137216
  v_add_u32 v10, s10, v10
  ds_write_b64 v10, v[12:13]
  s_waitcnt lgkmcnt(0)
  s_mov_b64 exec, 1
  ds_add_u32 v3, v2 offset:0
  s_mov_b64 exec, -1
  s_branch L_HC1
L_HLM:
  s_lshl_b32 s13, s4, 2
  s_add_u32 s13, s13, s5
  s_sub_u32 s13, s13, 4
  s_lshl_b32 s13, s13, 1
  s_add_u32 s13, s13, s15
  s_mov_b32 s56, s34
  s_mov_b32 s57, s35
  s_mov_b32 s58, 0x1000
  s_mov_b32 s59, 0x20000
  s_lshl_b32 s10, s6, 9
  v_lshlrev_b32 v10, 3, v0
  buffer_load_dwordx2 v[12:13], v10, s[56:59], s10 offen
  s_cmp_lg_u32 s6, 0
  s_cbranch_scc1 NZ_19
  v_lshlrev_b32 v10, 2, v0
  v_mov_b32 v11, 0
  v_add_u32 v10, 131072, v10
  ds_write_b32 v10, v11
  s_waitcnt lgkmcnt(0)
NZ_19:
  s_barrier
  s_waitcnt lgkmcnt(0)
  s_mul_i32 s78, s64, 0x9E3779B1
  s_add_u32 s78, s78, 0x7F4A7C15
  s_and_b32 s60, s78, 0xff
  s_bfe_u32 s61, s78, 0x80008
  s_bfe_u32 s62, s78, 0x80010
  s_lshr_b32 s63, s78, 24
  s_mov_b32 s0, s78
  s_mov_b32 s1, 0xffffff00
  s_mov_b32 s26, 0x0c0c0400
  s_mov_b32 s27, 0x04000c0c
  s_waitcnt vmcnt(0)
  v_lshlrev_b32 v16, 16, v12
  v_and_b32 v17, s70, v12
  v_lshlrev_b32 v18, 16, v13
  v_and_b32 v19, s70, v13
  v_mul_f32 v20, 0xbfb8aa3b, v16
  v_mul_f32 v21, 0xbfb8aa3b, v17
  v_mul_f32 v22, 0xbfb8aa3b, v18
  v_mul_f32 v23, 0xbfb8aa3b, v19
  v_exp_f32 v20, v20
  v_exp_f32 v21, v21
  v_exp_f32 v22, v22
  v_exp_f32 v23, v23
  v_add_f32 v20, 1.0, v20
  v_add_f32 v21, 1.0, v21
  v_add_f32 v22, 1.0, v22
  v_add_f32 v23, 1.0, v23
  v_rcp_f32 v20, v20
  v_rcp_f32 v21, v21
  v_rcp_f32 v22, v22
  v_rcp_f32 v23, v23
  v_mul_f32 v16, v16, v20
  v_mul_f32 v17, v17, v21
  v_mul_f32 v18, v18, v22
  v_mul_f32 v19, v19, v23
  v_cvt_pk_bf16_f32 v12, v16, v17
  v_cvt_pk_bf16_f32 v13, v18, v19
  v_lshlrev_b32 v10, 3, v0
  s_lshl_b32 s10, s6, 9
  s_add_u32 s10, s10, 137216
  v_add_u32 v10, s10, v10
  ds_write_b64 v10, v[12:13]
  s_waitcnt lgkmcnt(0)
  s_mov_b64 exec, 1
  ds_add_u32 v3, v2 offset:0
  s_mov_b64 exec, -1
  s_mov_b32 s44, s36
  s_mov_b32 s45, s37
  s_mov_b32 s46, 0x300000
  s_mov_b32 s47, 0x20000
  v_lshrrev_b32 v10, 3, v0
  v_mul_u32_u24 v10, 49152, v10
  v_and_b32 v11, 7, v0
  v_lshl_add_u32 v10, v11, 4, v10
  s_mul_i32 s10, s6, 393216
  s_lshr_b32 s11, s13, 1
  s_lshl_b32 s11, s11, 7
  s_add_u32 s10, s10, s11
  s_waitcnt vmcnt(1)
  buffer_load_dwordx4 v[96:99], v10, s[44:47], s10 offen nt
  s_waitcnt vmcnt(1)
  s_add_u32 s11, s10, 6144
  buffer_load_dwordx4 v[100:103], v10, s[44:47], s11 offen nt
  s_waitcnt vmcnt(1)
  s_add_u32 s11, s10, 12288
  buffer_load_dwordx4 v[104:107], v10, s[44:47], s11 offen nt
  s_waitcnt vmcnt(1)
  s_add_u32 s11, s10, 18432
  buffer_load_dwordx4 v[108:111], v10, s[44:47], s11 offen nt
  s_waitcnt vmcnt(1)
  s_add_u32 s11, s10, 24576
  buffer_load_dwordx4 v[112:115], v10, s[44:47], s11 offen nt
  s_waitcnt vmcnt(1)
  s_add_u32 s11, s10, 30720
  buffer_load_dwordx4 v[116:119], v10, s[44:47], s11 offen nt
  s_waitcnt vmcnt(1)
  s_add_u32 s11, s10, 36864
  buffer_load_dwordx4 v[120:123], v10, s[44:47], s11 offen nt
  s_waitcnt vmcnt(1)
  s_add_u32 s11, s10, 43008
  buffer_load_dwordx4 v[124:127], v10, s[44:47], s11 offen nt
  v_and_b32 v10, 3, v0
  v_lshlrev_b32 v11, 10, v10
  v_lshrrev_b32 v12, 4, v0
  v_lshl_add_u32 v11, v12, 5, v11
  v_bfe_u32 v12, v0, 2, 1
  v_lshl_add_u32 v11, v12, 4, v11
  s_lshl_b32 s10, s6, 7
  s_add_u32 s10, s10, 137216
  v_add_u32 v11, s10, v11
  v_bfe_u32 v12, v0, 4, 1
  v_lshlrev_b32 v12, 4, v12
  v_lshrrev_b32 v13, 5, v0
  v_add_u32 v12, v12, v13
  s_lshl_b32 s10, s6, 1
  v_add_u32 v12, s10, v12
  v_mul_u32_u24 v12, 528, v12
  v_lshl_add_u32 v12, v10, 4, v12
  v_add_u32 v12, 141312, v12
  v_and_b32 v13, 7, v0
  v_mul_u32_u24 v13, 528, v13
  v_lshrrev_b32 v14, 3, v0
  v_lshl_add_u32 v13, v14, 6, v13
  s_and_b32 s10, s6, 3
  s_lshr_b32 s15, s6, 2
  s_lshl_b32 s11, s10, 4
  s_mul_i32 s12, s15, 8448
  s_add_u32 s11, s11, s12
  s_add_u32 s11, s11, 141312
  v_add_u32 v13, s11, v13
  v_lshlrev_b32 v14, 4, v14
  s_mul_i32 s10, s10, 12288
  s_lshl_b32 s11, s13, 7
  s_add_u32 s10, s10, s11
  s_add_u32 s12, s10, 65536
  s_mov_b32 s69, 400000
W_20:
  ds_read_b32 v4, v3 offset:0
  s_waitcnt lgkmcnt(0)
  v_cmp_gt_u32 vcc, 8, v4
  s_nop 0
  s_cbranch_vccz WD_21
  s_sub_u32 s69, s69, 1
  s_cbranch_scc0 W_20
WD_21:
  ds_read_b128 v[24:27], v11
  s_waitcnt vmcnt(0) lgkmcnt(0)
  v_perm_b32 v16, v100, v96, s71
  v_perm_b32 v17, v108, v104, s71
  v_perm_b32 v18, v116, v112, s71
  v_perm_b32 v19, v124, v120, s71
  v_perm_b32 v20, v100, v96, s72
  v_perm_b32 v21, v108, v104, s72
  v_perm_b32 v22, v116, v112, s72
  v_perm_b32 v23, v124, v120, s72
  v_mfma_f32_16x16x32_bf16 v[32:35], v[16:19], v[24:27], 0
  s_nop 0
  v_mfma_f32_16x16x32_bf16 v[36:39], v[20:23], v[24:27], 0
  v_perm_b32 v16, v101, v97, s71
  v_perm_b32 v17, v109, v105, s71
  v_perm_b32 v18, v117, v113, s71
  v_perm_b32 v19, v125, v121, s71
  v_perm_b32 v20, v101, v97, s72
  v_perm_b32 v21, v109, v105, s72
  v_perm_b32 v22, v117, v113, s72
  v_perm_b32 v23, v125, v121, s72
  v_mfma_f32_16x16x32_bf16 v[40:43], v[16:19], v[24:27], 0
  s_nop 0
  v_mfma_f32_16x16x32_bf16 v[44:47], v[20:23], v[24:27], 0
  v_perm_b32 v16, v102, v98, s71
  v_perm_b32 v17, v110, v106, s71
  v_perm_b32 v18, v118, v114, s71
  v_perm_b32 v19, v126, v122, s71
  v_perm_b32 v20, v102, v98, s72
  v_perm_b32 v21, v110, v106, s72
  v_perm_b32 v22, v118, v114, s72
  v_perm_b32 v23, v126, v122, s72
  v_mfma_f32_16x16x32_bf16 v[48:51], v[16:19], v[24:27], 0
  s_nop 0
  v_mfma_f32_16x16x32_bf16 v[52:55], v[20:23], v[24:27], 0
  v_perm_b32 v16, v103, v99, s71
  v_perm_b32 v17, v111, v107, s71
  v_perm_b32 v18, v119, v115, s71
  v_perm_b32 v19, v127, v123, s71
  v_perm_b32 v20, v103, v99, s72
  v_perm_b32 v21, v111, v107, s72
  v_perm_b32 v22, v119, v115, s72
  v_perm_b32 v23, v127, v123, s72
  v_mfma_f32_16x16x32_bf16 v[56:59], v[16:19], v[24:27], 0
  s_nop 0
  v_mfma_f32_16x16x32_bf16 v[60:63], v[20:23], v[24:27], 0
  s_mov_b32 exec_lo, 0xf000f
  s_mov_b32 exec_hi, 0xf000f0
  ds_write_b128 v12, v[32:35] offset:0
  ds_write_b128 v12, v[36:39] offset:64
  ds_write_b128 v12, v[40:43] offset:128
  ds_write_b128 v12, v[44:47] offset:192
  ds_write_b128 v12, v[48:51] offset:256
  ds_write_b128 v12, v[52:55] offset:320
  ds_write_b128 v12, v[56:59] offset:384
  ds_write_b128 v12, v[60:63] offset:448
  s_mov_b64 exec, -1
  s_waitcnt lgkmcnt(0)
  s_mov_b64 exec, 1
  ds_add_u32 v3, v2 offset:4
  s_mov_b64 exec, -1
  s_mov_b32 s69, 400000
W_22:
  ds_read_b32 v4, v3 offset:4
  s_waitcnt lgkmcnt(0)
  v_cmp_gt_u32 vcc, 8, v4
  s_nop 0
  s_cbranch_vccz WD_23
  s_sub_u32 s69, s69, 1
  s_cbranch_scc0 W_22
WD_23:
  ds_read_b128 v[16:19], v13 offset:0
  ds_read_b128 v[20:23], v13 offset:4224
  s_waitcnt lgkmcnt(0)
  v_pk_add_f32 v[16:17], v[16:17], v[20:21]
  v_pk_add_f32 v[18:19], v[18:19], v[22:23]
  s_nop 0
  v_add_f32_dpp v16, v16, v16 quad_perm:[1,0,3,2] row_mask:0xf bank_mask:0xf
  v_add_f32_dpp v17, v17, v17 quad_perm:[1,0,3,2] row_mask:0xf bank_mask:0xf
  v_add_f32_dpp v18, v18, v18 quad_perm:[1,0,3,2] row_mask:0xf bank_mask:0xf
  v_add_f32_dpp v19, v19, v19 quad_perm:[1,0,3,2] row_mask:0xf bank_mask:0xf
  v_add_f32_dpp v16, v16, v16 quad_perm:[2,3,0,1] row_mask:0xf bank_mask:0xf
  v_add_f32_dpp v17, v17, v17 quad_perm:[2,3,0,1] row_mask:0xf bank_mask:0xf
  v_add_f32_dpp v18, v18, v18 quad_perm:[2,3,0,1] row_mask:0xf bank_mask:0xf
  v_add_f32_dpp v19, v19, v19 quad_perm:[2,3,0,1] row_mask:0xf bank_mask:0xf
  v_add_f32_dpp v16, v16, v16 row_half_mirror row_mask:0xf bank_mask:0xf
  v_add_f32_dpp v17, v17, v17 row_half_mirror row_mask:0xf bank_mask:0xf
  v_add_f32_dpp v18, v18, v18 row_half_mirror row_mask:0xf bank_mask:0xf
  v_add_f32_dpp v19, v19, v19 row_half_mirror row_mask:0xf bank_mask:0xf
  v_cvt_pk_bf16_f32 v20, v16, v17
  v_cvt_pk_bf16_f32 v21, v18, v19
  v_lshl_or_b32 v16, v20, 16, s60
  v_and_b32 v17, s70, v20
  v_lshl_or_b32 v18, v21, 16, s62
  v_and_b32 v19, s70, v21
  v_or_b32 v17, s61, v17
  v_or_b32 v19, s63, v19
  s_mov_b32 exec_lo, 0x1010101
  s_mov_b32 exec_hi, 0x1010101
  buffer_store_dwordx4 v[16:19], v14, s[52:55], s12 offen sc1
  s_mov_b64 exec, -1
  s_branch L_HC1
L_HQR:
  s_lshl_b32 s13, s4, 3
  s_add_u32 s13, s13, s5
  s_lshl_b32 s13, s13, 1
  s_add_u32 s13, s13, s15
  s_cmp_ge_u32 s6, 4
  s_cbranch_scc1 XL_24
  s_mov_b32 s56, s16
  s_mov_b32 s57, s17
  s_mov_b32 s58, 0x1000
  s_mov_b32 s59, 0x20000
  s_lshl_b32 s10, s6, 10
  v_lshlrev_b32 v10, 4, v0
  buffer_load_dwordx4 v[28:31], v10, s[56:59], s10 offen
XL_24:
  s_mov_b32 s48, s22
  s_mov_b32 s49, s23
  s_mov_b32 s50, 0x400000
  s_mov_b32 s51, 0x20000
  v_lshrrev_b32 v10, 5, v0
  v_lshlrev_b32 v10, 5, v10
  v_bfe_u32 v11, v0, 3, 2
  v_lshl_add_u32 v10, v11, 1, v10
  v_lshlrev_b32 v10, 13, v10
  v_and_b32 v11, 7, v0
  v_lshl_add_u32 v10, v11, 4, v10
  s_lshl_b32 s10, s6, 19
  s_lshr_b32 s11, s13, 1
  s_lshl_b32 s11, s11, 7
  s_add_u32 s10, s10, s11
  buffer_load_dwordx4 v[64:67], v10, s[48:51], s10 offen nt
  s_add_u32 s11, s10, 65536
  buffer_load_dwordx4 v[68:71], v10, s[48:51], s11 offen nt
  s_add_u32 s11, s10, 131072
  buffer_load_dwordx4 v[72:75], v10, s[48:51], s11 offen nt
  s_add_u32 s11, s10, 196608
  buffer_load_dwordx4 v[76:79], v10, s[48:51], s11 offen nt
  s_add_u32 s11, s10, 8192
  buffer_load_dwordx4 v[80:83], v10, s[48:51], s11 offen nt
  s_add_u32 s11, s10, 73728
  buffer_load_dwordx4 v[84:87], v10, s[48:51], s11 offen nt
  s_add_u32 s11, s10, 139264
  buffer_load_dwordx4 v[88:91], v10, s[48:51], s11 offen nt
  s_add_u32 s11, s10, 204800
  buffer_load_dwordx4 v[92:95], v10, s[48:51], s11 offen nt
  s_cmp_lg_u32 s6, 0
  s_cbranch_scc1 NZ_25
  v_lshlrev_b32 v10, 2, v0
  v_mov_b32 v11, 0
  v_add_u32 v10, 131072, v10
  ds_write_b32 v10, v11
  s_waitcnt lgkmcnt(0)
NZ_25:
  s_barrier
  s_waitcnt lgkmcnt(0)
  s_mul_i32 s78, s64, 0x9E3779B1
  s_add_u32 s78, s78, 0x7F4A7C15
  s_and_b32 s60, s78, 0xff
  s_bfe_u32 s61, s78, 0x80008
  s_bfe_u32 s62, s78, 0x80010
  s_lshr_b32 s63, s78, 24
  s_mov_b32 s0, s78
  s_mov_b32 s1, 0xffffff00
  s_mov_b32 s26, 0x0c0c0400
  s_mov_b32 s27, 0x04000c0c
  s_cmp_ge_u32 s6, 4
  s_cbranch_scc1 Q4_26
  v_lshrrev_b32 v10, 2, v0
  v_lshlrev_b32 v10, 6, v10
  v_and_b32 v11, 3, v0
  v_lshl_add_u32 v10, v11, 1, v10
  s_lshl_b32 s10, s6, 10
  s_add_u32 s10, s10, 153600
  v_add_u32 v10, s10, v10
  s_waitcnt vmcnt(8)
  ds_write_b16 v10, v28 offset:0
  ds_write_b16_d16_hi v10, v28 offset:8
  ds_write_b16 v10, v29 offset:16
  ds_write_b16_d16_hi v10, v29 offset:24
  ds_write_b16 v10, v30 offset:32
  ds_write_b16_d16_hi v10, v30 offset:40
  ds_write_b16 v10, v31 offset:48
  ds_write_b16_d16_hi v10, v31 offset:56
  v_lshlrev_b32 v10, 4, v0
  s_lshl_b32 s10, s6, 10
  s_add_u32 s11, s10, 153600
  v_add_u32 v11, s11, v10
  ds_read_b128 v[16:19], v11
  s_add_u32 s11, s10, 137216
  v_add_u32 v15, s11, v10
  v_lshlrev_b32 v10, 5, v0
  s_mul_i32 s10, s6, 12288
  s_add_u32 s10, s10, 65536
  s_waitcnt lgkmcnt(0)
  v_lshlrev_b32 v20, 16, v16
  v_and_b32 v21, s70, v16
  v_lshlrev_b32 v22, 16, v17
  v_and_b32 v23, s70, v17
  v_lshlrev_b32 v24, 16, v18
  v_and_b32 v25, s70, v18
  v_lshlrev_b32 v26, 16, v19
  v_and_b32 v27, s70, v19
  v_add_f32 v36, v20, v21
  v_mul_f32 v37, v20, v20
  v_fmac_f32 v37, v21, v21
  v_add_f32 v36, v36, v22
  v_fmac_f32 v37, v22, v22
  v_add_f32 v36, v36, v23
  v_fmac_f32 v37, v23, v23
  v_add_f32 v36, v36, v24
  v_fmac_f32 v37, v24, v24
  v_add_f32 v36, v36, v25
  v_fmac_f32 v37, v25, v25
  v_add_f32 v36, v36, v26
  v_fmac_f32 v37, v26, v26
  v_add_f32 v36, v36, v27
  v_fmac_f32 v37, v27, v27
  s_nop 0
  v_add_f32_dpp v36, v36, v36 quad_perm:[1,0,3,2] row_mask:0xf bank_mask:0xf
  v_add_f32_dpp v37, v37, v37 quad_perm:[1,0,3,2] row_mask:0xf bank_mask:0xf
  s_nop 0
  v_add_f32_dpp v36, v36, v36 quad_perm:[2,3,0,1] row_mask:0xf bank_mask:0xf
  v_add_f32_dpp v37, v37, v37 quad_perm:[2,3,0,1] row_mask:0xf bank_mask:0xf
  s_nop 0
  v_add_f32_dpp v36, v36, v36 row_half_mirror row_mask:0xf bank_mask:0xf
  v_add_f32_dpp v37, v37, v37 row_half_mirror row_mask:0xf bank_mask:0xf
  s_nop 0
  v_add_f32_dpp v36, v36, v36 row_mirror row_mask:0xf bank_mask:0xf
  v_add_f32_dpp v37, v37, v37 row_mirror row_mask:0xf bank_mask:0xf
  v_mov_b32 v38, v36
  v_mov_b32 v39, v37
  s_nop 0
  v_permlane16_swap_b32 v36, v38
  v_permlane16_swap_b32 v37, v39
  v_add_f32 v36, v36, v38
  v_add_f32 v37, v37, v39
  v_mov_b32 v38, v36
  v_mov_b32 v39, v37
  s_nop 0
  v_permlane32_swap_b32 v36, v38
  v_permlane32_swap_b32 v37, v39
  v_add_f32 v36, v36, v38
  v_add_f32 v37, v37, v39
  v_mul_f32 v36, 0x3b000000, v36
  v_mul_f32 v37, 0x3b000000, v37
  v_fma_f32 v37, -v36, v36, v37
  v_max_f32 v37, 0, v37
  v_cvt_pk_bf16_f32 v38, v36, v37
  v_lshlrev_b32 v36, 16, v38
  v_and_b32 v37, s70, v38
  v_add_f32 v37, 0x3727c5ac, v37
  v_cvt_pk_bf16_f32 v38, v37, v37
  v_lshlrev_b32 v37, 16, v38
  v_sqrt_f32 v37, v37
  s_nop 0
  v_cvt_pk_bf16_f32 v38, v37, v37
  v_lshlrev_b32 v37, 16, v38
  v_rcp_f32 v37, v37
  v_sub_f32 v28, v20, v36
  v_sub_f32 v29, v21, v36
  v_sub_f32 v30, v22, v36
  v_sub_f32 v31, v23, v36
  v_sub_f32 v32, v24, v36
  v_sub_f32 v33, v25, v36
  v_sub_f32 v34, v26, v36
  v_sub_f32 v35, v27, v36
  v_cvt_pk_bf16_f32 v38, v28, v29
  v_lshlrev_b32 v28, 16, v38
  v_and_b32 v29, s70, v38
  v_cvt_pk_bf16_f32 v39, v30, v31
  v_lshlrev_b32 v30, 16, v39
  v_and_b32 v31, s70, v39
  v_cvt_pk_bf16_f32 v38, v32, v33
  v_lshlrev_b32 v32, 16, v38
  v_and_b32 v33, s70, v38
  v_cvt_pk_bf16_f32 v39, v34, v35
  v_lshlrev_b32 v34, 16, v39
  v_and_b32 v35, s70, v39
  v_mul_f32 v28, v28, v37
  v_mul_f32 v29, v29, v37
  v_mul_f32 v30, v30, v37
  v_mul_f32 v31, v31, v37
  v_mul_f32 v32, v32, v37
  v_mul_f32 v33, v33, v37
  v_mul_f32 v34, v34, v37
  v_mul_f32 v35, v35, v37
  v_cvt_pk_bf16_f32 v38, v28, v29
  v_lshlrev_b32 v28, 16, v38
  v_and_b32 v29, s70, v38
  v_cvt_pk_bf16_f32 v39, v30, v31
  v_lshlrev_b32 v30, 16, v39
  v_and_b32 v31, s70, v39
  v_cvt_pk_bf16_f32 v38, v32, v33
  v_lshlrev_b32 v32, 16, v38
  v_and_b32 v33, s70, v38
  v_cvt_pk_bf16_f32 v39, v34, v35
  v_lshlrev_b32 v34, 16, v39
  v_and_b32 v35, s70, v39
  s_mov_b32 s69, 400000
  s_mov_b64 s[16:17], exec
  s_mov_b64 s[18:19], exec
  s_mov_b64 s[20:21], exec
  s_mov_b64 s[22:23], exec
G_28:
  s_mov_b64 exec, s[16:17]
  buffer_load_dwordx4 v[40:43], v10, s[52:55], s10 offen offset:0 sc1
  s_mov_b64 exec, s[18:19]
  buffer_load_dwordx4 v[44:47], v10, s[52:55], s10 offen offset:16 sc1
  s_mov_b64 exec, s[20:21]
  buffer_load_dwordx4 v[48:51], v10, s[52:55], s10 offen offset:2048 sc1
  s_mov_b64 exec, s[22:23]
  buffer_load_dwordx4 v[52:55], v10, s[52:55], s10 offen offset:2064 sc1
  s_waitcnt vmcnt(0)
  s_mov_b64 exec, s[16:17]
  s_cbranch_execz GS_30
  v_perm_b32 v11, v41, v40, s26
  v_perm_b32 v12, v43, v42, s27
  v_or_b32 v11, v11, v12
  v_cmp_ne_u32 s[16:17], s0, v11
GS_30:
  s_mov_b64 exec, s[18:19]
  s_cbranch_execz GS_31
  v_perm_b32 v11, v45, v44, s26
  v_perm_b32 v12, v47, v46, s27
  v_or_b32 v11, v11, v12
  v_cmp_ne_u32 s[18:19], s0, v11
GS_31:
  s_mov_b64 exec, s[20:21]
  s_cbranch_execz GS_32
  v_perm_b32 v11, v49, v48, s26
  v_perm_b32 v12, v51, v50, s27
  v_or_b32 v11, v11, v12
  v_cmp_ne_u32 s[20:21], s0, v11
GS_32:
  s_mov_b64 exec, s[22:23]
  s_cbranch_execz GS_33
  v_perm_b32 v11, v53, v52, s26
  v_perm_b32 v12, v55, v54, s27
  v_or_b32 v11, v11, v12
  v_cmp_ne_u32 s[22:23], s0, v11
GS_33:
  s_or_b64 vcc, s[16:17], s[18:19]
  s_or_b64 vcc, vcc, s[20:21]
  s_or_b64 vcc, vcc, s[22:23]
  s_cbranch_scc0 GD_29
  s_sub_u32 s69, s69, 1
  s_cbranch_scc0 G_28
GD_29:
  s_mov_b64 exec, -1
  v_and_b32 v40, s1, v40
  v_and_b32 v41, s1, v41
  v_and_b32 v42, s1, v42
  v_and_b32 v43, s1, v43
  v_and_b32 v44, s1, v44
  v_and_b32 v45, s1, v45
  v_and_b32 v46, s1, v46
  v_and_b32 v47, s1, v47
  v_and_b32 v48, s1, v48
  v_and_b32 v49, s1, v49
  v_and_b32 v50, s1, v50
  v_and_b32 v51, s1, v51
  v_and_b32 v52, s1, v52
  v_and_b32 v53, s1, v53
  v_and_b32 v54, s1, v54
  v_and_b32 v55, s1, v55
  v_add_f32 v48, 1.0, v48
  v_add_f32 v49, 1.0, v49
  v_add_f32 v50, 1.0, v50
  v_add_f32 v51, 1.0, v51
  v_add_f32 v52, 1.0, v52
  v_add_f32 v53, 1.0, v53
  v_add_f32 v54, 1.0, v54
  v_add_f32 v55, 1.0, v55
  v_cvt_pk_bf16_f32 v12, v48, v49
  v_lshlrev_b32 v48, 16, v12
  v_and_b32 v49, s70, v12
  v_cvt_pk_bf16_f32 v13, v50, v51
  v_lshlrev_b32 v50, 16, v13
  v_and_b32 v51, s70, v13
  v_cvt_pk_bf16_f32 v12, v52, v53
  v_lshlrev_b32 v52, 16, v12
  v_and_b32 v53, s70, v12
  v_cvt_pk_bf16_f32 v13, v54, v55
  v_lshlrev_b32 v54, 16, v13
  v_and_b32 v55, s70, v13
  v_mul_f32 v48, v28, v48
  v_mul_f32 v49, v29, v49
  v_mul_f32 v50, v30, v50
  v_mul_f32 v51, v31, v51
  v_mul_f32 v52, v32, v52
  v_mul_f32 v53, v33, v53
  v_mul_f32 v54, v34, v54
  v_mul_f32 v55, v35, v55
  v_cvt_pk_bf16_f32 v12, v48, v49
  v_lshlrev_b32 v48, 16, v12
  v_and_b32 v49, s70, v12
  v_cvt_pk_bf16_f32 v13, v50, v51
  v_lshlrev_b32 v50, 16, v13
  v_and_b32 v51, s70, v13
  v_cvt_pk_bf16_f32 v12, v52, v53
  v_lshlrev_b32 v52, 16, v12
  v_and_b32 v53, s70, v12
  v_cvt_pk_bf16_f32 v13, v54, v55
  v_lshlrev_b32 v54, 16, v13
  v_and_b32 v55, s70, v13
  v_add_f32 v48, v48, v40
  v_add_f32 v49, v49, v41
  v_add_f32 v50, v50, v42
  v_add_f32 v51, v51, v43
  v_add_f32 v52, v52, v44
  v_add_f32 v53, v53, v45
  v_add_f32 v54, v54, v46
  v_add_f32 v55, v55, v47
  v_cvt_pk_bf16_f32 v16, v48, v49
  v_cvt_pk_bf16_f32 v17, v50, v51
  v_cvt_pk_bf16_f32 v18, v52, v53
  v_cvt_pk_bf16_f32 v19, v54, v55
  ds_write_b128 v15, v[16:19]
  s_waitcnt lgkmcnt(0)
  s_mov_b64 exec, 1
  ds_add_u32 v3, v2 offset:20
  s_mov_b64 exec, -1
  s_branch QC_27
Q4_26:
QC_27:
  v_and_b32 v10, 3, v0
  v_lshlrev_b32 v11, 10, v10
  v_lshrrev_b32 v12, 4, v0
  v_lshl_add_u32 v11, v12, 5, v11
  v_bfe_u32 v12, v0, 2, 1
  v_lshl_add_u32 v11, v12, 4, v11
  s_lshl_b32 s10, s6, 7
  s_add_u32 s10, s10, 137216
  v_add_u32 v11, s10, v11
  v_bfe_u32 v12, v0, 4, 1
  v_lshlrev_b32 v12, 4, v12
  v_lshrrev_b32 v13, 5, v0
  v_add_u32 v12, v12, v13
  s_lshl_b32 s10, s6, 1
  v_add_u32 v12, s10, v12
  v_mul_u32_u24 v12, 528, v12
  v_lshl_add_u32 v12, v10, 4, v12
  v_add_u32 v12, 141312, v12
  v_and_b32 v13, 7, v0
  v_mul_u32_u24 v13, 528, v13
  v_lshrrev_b32 v14, 3, v0
  v_lshl_add_u32 v13, v14, 6, v13
  s_and_b32 s10, s6, 3
  s_lshr_b32 s15, s6, 2
  s_lshl_b32 s11, s10, 4
  s_mul_i32 s12, s15, 8448
  s_add_u32 s11, s11, s12
  s_add_u32 s11, s11, 141312
  v_add_u32 v13, s11, v13
  v_lshlrev_b32 v14, 4, v14
  s_mul_i32 s10, s10, 16384
  s_lshl_b32 s11, s13, 7
  s_add_u32 s10, s10, s11
  s_add_u32 s12, s10, 131072
  s_mov_b32 s69, 400000
W_34:
  ds_read_b32 v4, v3 offset:20
  s_waitcnt lgkmcnt(0)
  v_cmp_gt_u32 vcc, 4, v4
  s_nop 0
  s_cbranch_vccz WD_35
  s_sleep 1
  s_sub_u32 s69, s69, 1
  s_cbranch_scc0 W_34
WD_35:
  ds_read_b128 v[24:27], v11
  s_waitcnt vmcnt(0) lgkmcnt(0)
  v_perm_b32 v16, v68, v64, s71
  v_perm_b32 v17, v76, v72, s71
  v_perm_b32 v18, v84, v80, s71
  v_perm_b32 v19, v92, v88, s71
  v_perm_b32 v20, v68, v64, s72
  v_perm_b32 v21, v76, v72, s72
  v_perm_b32 v22, v84, v80, s72
  v_perm_b32 v23, v92, v88, s72
  v_mfma_f32_16x16x32_bf16 v[32:35], v[16:19], v[24:27], 0
  s_nop 0
  v_mfma_f32_16x16x32_bf16 v[36:39], v[20:23], v[24:27], 0
  v_perm_b32 v16, v69, v65, s71
  v_perm_b32 v17, v77, v73, s71
  v_perm_b32 v18, v85, v81, s71
  v_perm_b32 v19, v93, v89, s71
  v_perm_b32 v20, v69, v65, s72
  v_perm_b32 v21, v77, v73, s72
  v_perm_b32 v22, v85, v81, s72
  v_perm_b32 v23, v93, v89, s72
  v_mfma_f32_16x16x32_bf16 v[40:43], v[16:19], v[24:27], 0
  s_nop 0
  v_mfma_f32_16x16x32_bf16 v[44:47], v[20:23], v[24:27], 0
  v_perm_b32 v16, v70, v66, s71
  v_perm_b32 v17, v78, v74, s71
  v_perm_b32 v18, v86, v82, s71
  v_perm_b32 v19, v94, v90, s71
  v_perm_b32 v20, v70, v66, s72
  v_perm_b32 v21, v78, v74, s72
  v_perm_b32 v22, v86, v82, s72
  v_perm_b32 v23, v94, v90, s72
  v_mfma_f32_16x16x32_bf16 v[48:51], v[16:19], v[24:27], 0
  s_nop 0
  v_mfma_f32_16x16x32_bf16 v[52:55], v[20:23], v[24:27], 0
  v_perm_b32 v16, v71, v67, s71
  v_perm_b32 v17, v79, v75, s71
  v_perm_b32 v18, v87, v83, s71
  v_perm_b32 v19, v95, v91, s71
  v_perm_b32 v20, v71, v67, s72
  v_perm_b32 v21, v79, v75, s72
  v_perm_b32 v22, v87, v83, s72
  v_perm_b32 v23, v95, v91, s72
  v_mfma_f32_16x16x32_bf16 v[56:59], v[16:19], v[24:27], 0
  s_nop 0
  v_mfma_f32_16x16x32_bf16 v[60:63], v[20:23], v[24:27], 0
  s_mov_b32 exec_lo, 0xf000f
  s_mov_b32 exec_hi, 0xf000f0
  ds_write_b128 v12, v[32:35] offset:0
  ds_write_b128 v12, v[36:39] offset:64
  ds_write_b128 v12, v[40:43] offset:128
  ds_write_b128 v12, v[44:47] offset:192
  ds_write_b128 v12, v[48:51] offset:256
  ds_write_b128 v12, v[52:55] offset:320
  ds_write_b128 v12, v[56:59] offset:384
  ds_write_b128 v12, v[60:63] offset:448
  s_mov_b64 exec, -1
  s_waitcnt lgkmcnt(0)
  s_mov_b64 exec, 1
  ds_add_u32 v3, v2 offset:4
  s_mov_b64 exec, -1
  s_mov_b32 s69, 400000
W_36:
  ds_read_b32 v4, v3 offset:4
  s_waitcnt lgkmcnt(0)
  v_cmp_gt_u32 vcc, 8, v4
  s_nop 0
  s_cbranch_vccz WD_37
  s_sub_u32 s69, s69, 1
  s_cbranch_scc0 W_36
WD_37:
  ds_read_b128 v[16:19], v13 offset:0
  ds_read_b128 v[20:23], v13 offset:4224
  s_waitcnt lgkmcnt(0)
  v_pk_add_f32 v[16:17], v[16:17], v[20:21]
  v_pk_add_f32 v[18:19], v[18:19], v[22:23]
  s_nop 0
  v_add_f32_dpp v16, v16, v16 quad_perm:[1,0,3,2] row_mask:0xf bank_mask:0xf
  v_add_f32_dpp v17, v17, v17 quad_perm:[1,0,3,2] row_mask:0xf bank_mask:0xf
  v_add_f32_dpp v18, v18, v18 quad_perm:[1,0,3,2] row_mask:0xf bank_mask:0xf
  v_add_f32_dpp v19, v19, v19 quad_perm:[1,0,3,2] row_mask:0xf bank_mask:0xf
  v_add_f32_dpp v16, v16, v16 quad_perm:[2,3,0,1] row_mask:0xf bank_mask:0xf
  v_add_f32_dpp v17, v17, v17 quad_perm:[2,3,0,1] row_mask:0xf bank_mask:0xf
  v_add_f32_dpp v18, v18, v18 quad_perm:[2,3,0,1] row_mask:0xf bank_mask:0xf
  v_add_f32_dpp v19, v19, v19 quad_perm:[2,3,0,1] row_mask:0xf bank_mask:0xf
  v_add_f32_dpp v16, v16, v16 row_half_mirror row_mask:0xf bank_mask:0xf
  v_add_f32_dpp v17, v17, v17 row_half_mirror row_mask:0xf bank_mask:0xf
  v_add_f32_dpp v18, v18, v18 row_half_mirror row_mask:0xf bank_mask:0xf
  v_add_f32_dpp v19, v19, v19 row_half_mirror row_mask:0xf bank_mask:0xf
  v_cvt_pk_bf16_f32 v20, v16, v17
  v_cvt_pk_bf16_f32 v21, v18, v19
  v_lshl_or_b32 v16, v20, 16, s60
  v_and_b32 v17, s70, v20
  v_lshl_or_b32 v18, v21, 16, s62
  v_and_b32 v19, s70, v21
  v_or_b32 v17, s61, v17
  v_or_b32 v19, s63, v19
  s_mov_b32 exec_lo, 0x1010101
  s_mov_b32 exec_hi, 0x1010101
  buffer_store_dwordx4 v[16:19], v14, s[52:55], s12 offen sc1
  s_mov_b64 exec, -1
L_HC1:
  s_and_b32 s10, s6, 6
  s_cmp_lg_u32 s10, 2
  s_cbranch_scc1 NOQ_38
  s_and_b32 s11, s6, 1
  s_lshl_b32 s12, s11, 2
  s_add_u32 s12, s12, 131112
  v_mov_b32 v14, s12
  s_lshl_b32 s11, s11, 6
  v_add_u32 v12, s11, v0
  v_lshlrev_b32 v10, 4, v12
  s_lshl_b32 s10, s65, 14
  s_lshl_b32 s11, s66, 11
  s_add_u32 s10, s10, s11
  s_add_u32 s10, s10, 131072
  v_lshrrev_b32 v13, 5, v12
  v_lshlrev_b32 v13, 8, v13
  v_bfe_u32 v11, v12, 3, 2
  v_lshl_add_u32 v13, v11, 6, v13
  v_and_b32 v11, 7, v12
  v_lshl_add_u32 v13, v11, 1, v13
  v_add_u32 v13, 131328, v13
  s_mov_b32 s69, 400000
QP_39:
  ds_read_b32 v4, v14
  buffer_load_dwordx4 v[16:19], v10, s[52:55], s10 offen sc1
  s_waitcnt vmcnt(0) lgkmcnt(0)
  v_cmp_ne_u32 vcc, 0, v4
  s_nop 0
  s_cbranch_vccnz NOQ_38
  v_perm_b32 v11, v17, v16, s26
  v_perm_b32 v12, v19, v18, s27
  v_or_b32 v11, v11, v12
  v_cmp_ne_u32 vcc, s0, v11
  s_nop 0
  s_cbranch_vccz QD_40
  s_sleep 2
  s_sub_u32 s69, s69, 1
  s_cbranch_scc0 QP_39
QD_40:
  ds_write_b16_d16_hi v13, v16 offset:0
  ds_write_b16_d16_hi v13, v17 offset:16
  ds_write_b16_d16_hi v13, v18 offset:32
  ds_write_b16_d16_hi v13, v19 offset:48
  s_waitcnt lgkmcnt(0)
  s_mov_b64 exec, 1
  ds_add_u32 v14, v2 offset:0
  s_mov_b64 exec, -1
NOQ_38:
  v_and_b32 v10, 3, v0
  v_lshrrev_b32 v11, 2, v6
  v_lshlrev_b32 v12, 10, v10
  v_lshl_add_u32 v12, v11, 8, v12
  v_add_u32 v12, s9, v12
  v_xor_b32 v13, v5, v11
  v_xor_b32 v14, 0, v10
  v_lshl_add_u32 v14, v14, 2, v13
  v_lshl_add_u32 v7, v14, 4, v12
  v_xor_b32 v14, 1, v10
  v_lshl_add_u32 v14, v14, 2, v13
  v_lshl_add_u32 v8, v14, 4, v12
  v_xor_b32 v14, 2, v10
  v_lshl_add_u32 v14, v14, 2, v13
  v_lshl_add_u32 v9, v14, 4, v12
  v_xor_b32 v14, 3, v10
  v_lshl_add_u32 v14, v14, 2, v13
  v_lshl_add_u32 v15, v14, 4, v12
  v_lshlrev_b32 v12, 8, v10
  v_lshl_add_u32 v12, v5, 4, v12
  v_add_u32 v12, 131328, v12
  s_mov_b32 s8, 1
  s_cmp_ge_u32 s5, 99
  s_cselect_b32 s8, 0, s8
  s_sub_u32 s10, s5, 8
  s_cmp_lt_u32 s10, 7
  s_cselect_b32 s8, 0, s8
  s_mov_b32 s10, s8
  s_mov_b32 s69, 400000
L_WQ:
  ds_read_b64 v[18:19], v3 offset:40
  ds_read_b32 v14, v1 offset:128
  s_waitcnt lgkmcnt(0)
  v_min_u32 v4, v18, v19
  v_cmp_eq_u32 vcc, 0, v4
  s_nop 0
  s_cbranch_vccz L_WQD
  s_cmp_lg_u32 s8, 7
  s_cbranch_scc1 L_WQS
  v_cmp_eq_u32 vcc, 0, v14
  s_nop 0
  s_cbranch_vccz L_TW
L_WQS:
  s_sleep 2
  s_sub_u32 s69, s69, 1
  s_cbranch_scc0 L_WQ
L_WQD:
  ds_read_b128 v[16:19], v12 offset:0
  ds_read_b128 v[20:23], v12 offset:64
  ds_read_b128 v[24:27], v12 offset:128
  ds_read_b128 v[28:31], v12 offset:192
  s_mov_b32 s69, 400000
W_41:
  ds_read_b32 v4, v1 offset:64
  s_waitcnt lgkmcnt(0)
  v_cmp_gt_u32 vcc, 1, v4
  s_nop 0
  s_cbranch_vccz WD_42
  s_sleep 1
  s_sub_u32 s69, s69, 1
  s_cbranch_scc0 W_41
WD_42:
  ds_read_b128 v[48:51], v7 offset:0
  ds_read_b128 v[52:55], v8 offset:0
  ds_read_b128 v[56:59], v9 offset:0
  ds_read_b128 v[60:63], v15 offset:0
  s_waitcnt lgkmcnt(3)
  v_mfma_f32_16x16x32_bf16 v[32:35], v[48:51], v[16:19], 0
  s_waitcnt lgkmcnt(2)
  v_mfma_f32_16x16x32_bf16 v[32:35], v[52:55], v[20:23], v[32:35]
  s_waitcnt lgkmcnt(1)
  v_mfma_f32_16x16x32_bf16 v[32:35], v[56:59], v[24:27], v[32:35]
  s_waitcnt lgkmcnt(0)
  v_mfma_f32_16x16x32_bf16 v[32:35], v[60:63], v[28:31], v[32:35]
  ds_read_b128 v[48:51], v7 offset:4096
  ds_read_b128 v[52:55], v8 offset:4096
  ds_read_b128 v[56:59], v9 offset:4096
  ds_read_b128 v[60:63], v15 offset:4096
  s_waitcnt lgkmcnt(3)
  v_mfma_f32_16x16x32_bf16 v[36:39], v[48:51], v[16:19], 0
  s_waitcnt lgkmcnt(2)
  v_mfma_f32_16x16x32_bf16 v[36:39], v[52:55], v[20:23], v[36:39]
  s_waitcnt lgkmcnt(1)
  v_mfma_f32_16x16x32_bf16 v[36:39], v[56:59], v[24:27], v[36:39]
  s_waitcnt lgkmcnt(0)
  v_mfma_f32_16x16x32_bf16 v[36:39], v[60:63], v[28:31], v[36:39]
  ds_read_b128 v[48:51], v7 offset:8192
  ds_read_b128 v[52:55], v8 offset:8192
  ds_read_b128 v[56:59], v9 offset:8192
  ds_read_b128 v[60:63], v15 offset:8192
  s_waitcnt lgkmcnt(3)
  v_mfma_f32_16x16x32_bf16 v[40:43], v[48:51], v[16:19], 0
  s_waitcnt lgkmcnt(2)
  v_mfma_f32_16x16x32_bf16 v[40:43], v[52:55], v[20:23], v[40:43]
  s_waitcnt lgkmcnt(1)
  v_mfma_f32_16x16x32_bf16 v[40:43], v[56:59], v[24:27], v[40:43]
  s_waitcnt lgkmcnt(0)
  v_mfma_f32_16x16x32_bf16 v[40:43], v[60:63], v[28:31], v[40:43]
  ds_read_b128 v[48:51], v7 offset:12288
  ds_read_b128 v[52:55], v8 offset:12288
  ds_read_b128 v[56:59], v9 offset:12288
  ds_read_b128 v[60:63], v15 offset:12288
  s_waitcnt lgkmcnt(3)
  v_mfma_f32_16x16x32_bf16 v[44:47], v[48:51], v[16:19], 0
  s_waitcnt lgkmcnt(2)
  v_mfma_f32_16x16x32_bf16 v[44:47], v[52:55], v[20:23], v[44:47]
  s_waitcnt lgkmcnt(1)
  v_mfma_f32_16x16x32_bf16 v[44:47], v[56:59], v[24:27], v[44:47]
  s_waitcnt lgkmcnt(0)
  v_mfma_f32_16x16x32_bf16 v[44:47], v[60:63], v[28:31], v[44:47]
  s_mov_b32 exec_lo, 0xf000f0
  s_mov_b32 exec_hi, 0xf000f0
  v_mov_b32 v32, v36
  v_mov_b32 v33, v37
  v_mov_b32 v34, v38
  v_mov_b32 v35, v39
  s_mov_b32 exec_lo, 0xf000f00
  s_mov_b32 exec_hi, 0xf000f00
  v_mov_b32 v32, v40
  v_mov_b32 v33, v41
  v_mov_b32 v34, v42
  v_mov_b32 v35, v43
  s_nop 15
  s_mov_b32 exec_lo, 0xf000f000
  s_mov_b32 exec_hi, 0xf000f000
  v_mov_b32 v32, v44
  v_mov_b32 v33, v45
  v_mov_b32 v34, v46
  v_mov_b32 v35, v47
  s_mov_b64 exec, -1
  v_cvt_pk_bf16_f32 v12, v32, v33
  v_lshlrev_b32 v32, 16, v12
  v_and_b32 v33, s70, v12
  v_cvt_pk_bf16_f32 v13, v34, v35
  v_lshlrev_b32 v34, 16, v13
  v_and_b32 v35, s70, v13
  v_mul_f32 v32, 0x3db504f3, v32
  v_mul_f32 v33, 0x3db504f3, v33
  v_mul_f32 v34, 0x3db504f3, v34
  v_mul_f32 v35, 0x3db504f3, v35
  v_cvt_pk_bf16_f32 v12, v32, v33
  v_lshlrev_b32 v32, 16, v12
  v_and_b32 v33, s70, v12
  v_cvt_pk_bf16_f32 v13, v34, v35
  v_lshlrev_b32 v34, 16, v13
  v_and_b32 v35, s70, v13
  v_max_f32 v16, v32, v33
  v_max3_f32 v16, v16, v34, v35
  s_nop 1
  v_max_f32_dpp v16, v16, v16 row_ror:4 row_mask:0xf bank_mask:0xf
  s_nop 1
  v_max_f32_dpp v16, v16, v16 row_ror:8 row_mask:0xf bank_mask:0xf
  v_mov_b32 v12, v16
  s_nop 1
  v_permlane16_swap_b32 v16, v12
  v_max_f32 v16, v16, v12
  v_mov_b32 v12, v16
  s_nop 1
  v_permlane32_swap_b32 v16, v12
  v_max_f32 v16, v16, v12
  v_lshlrev_b32 v10, 2, v0
  s_lshl_b32 s10, s6, 5
  s_add_u32 s10, s10, 132352
  v_add_u32 v10, s10, v10
  v_bfe_u32 v11, v0, 2, 3
  v_lshlrev_b32 v11, 5, v11
  v_and_b32 v12, 3, v0
  v_lshl_add_u32 v11, v12, 2, v11
  v_add_u32 v11, 132352, v11
  v_lshl_add_u32 v13, v5, 2, v12
  v_lshlrev_b32 v13, 4, v13
  v_bfe_u32 v12, v0, 3, 1
  v_lshl_add_u32 v13, v12, 8, v13
  v_bfe_u32 v12, v0, 2, 1
  v_lshl_add_u32 v13, v12, 3, v13
  s_lshl_b32 s10, s6, 9
  s_add_u32 s10, s10, 133120
  v_add_u32 v13, s10, v13
  s_mov_b64 exec, 15
  ds_write_b32 v10, v16
  s_mov_b64 exec, -1
  s_waitcnt lgkmcnt(0)
  s_mov_b64 exec, 1
  ds_add_u32 v3, v2 offset:16
  s_mov_b64 exec, -1
  s_mov_b32 s69, 400000
W_43:
  ds_read_b32 v4, v3 offset:16
  s_waitcnt lgkmcnt(0)
  v_cmp_gt_u32 vcc, 8, v4
  s_nop 0
  s_cbranch_vccz WD_44
  s_sub_u32 s69, s69, 1
  s_cbranch_scc0 W_43
WD_44:
  ds_read_b32 v16, v11
  s_waitcnt lgkmcnt(0)
  v_max_f32_dpp v16, v16, v16 row_ror:4 row_mask:0xf bank_mask:0xf
  s_nop 1
  v_max_f32_dpp v16, v16, v16 row_ror:8 row_mask:0xf bank_mask:0xf
  v_mov_b32 v12, v16
  s_nop 1
  v_permlane16_swap_b32 v16, v12
  v_max_f32 v16, v16, v12
  v_sub_f32 v48, v32, v16
  v_sub_f32 v49, v33, v16
  v_sub_f32 v50, v34, v16
  v_sub_f32 v51, v35, v16
  v_mul_f32 v48, 0x3fb8aa3b, v48
  v_mul_f32 v49, 0x3fb8aa3b, v49
  v_mul_f32 v50, 0x3fb8aa3b, v50
  v_mul_f32 v51, 0x3fb8aa3b, v51
  v_exp_f32 v48, v48
  v_exp_f32 v49, v49
  v_exp_f32 v50, v50
  v_exp_f32 v51, v51
  v_cvt_pk_bf16_f32 v32, v48, v49
  v_cvt_pk_bf16_f32 v33, v50, v51
  ds_write_b64 v13, v[32:33]
  s_waitcnt lgkmcnt(0)
  s_mov_b64 exec, 1
  ds_add_u32 v1, v2 offset:96
  s_mov_b64 exec, -1
  v_add_f32 v17, v48, v49
  v_add_f32 v17, v17, v50
  v_add_f32 v17, v17, v51
  s_nop 1
  v_add_f32_dpp v17, v17, v17 row_ror:4 row_mask:0xf bank_mask:0xf
  s_nop 1
  v_add_f32_dpp v17, v17, v17 row_ror:8 row_mask:0xf bank_mask:0xf
  v_mov_b32 v12, v17
  s_nop 1
  v_permlane16_swap_b32 v17, v12
  v_add_f32 v17, v17, v12
  v_mov_b32 v12, v17
  s_nop 1
  v_permlane32_swap_b32 v17, v12
  v_add_f32 v17, v17, v12
  s_mov_b64 exec, 15
  ds_write_b32 v10, v17 offset:16
  s_mov_b64 exec, -1
  s_waitcnt lgkmcnt(0)
  s_mov_b64 exec, 1
  ds_add_u32 v3, v2 offset:36
  s_mov_b64 exec, -1
  s_cmp_lg_u32 s6, 0
  s_cbranch_scc1 NOST_45
  s_mov_b32 s69, 400000
W_46:
  ds_read_b32 v4, v3 offset:36
  s_waitcnt lgkmcnt(0)
  v_cmp_gt_u32 vcc, 8, v4
  s_nop 0
  s_cbranch_vccz WD_47
  s_sub_u32 s69, s69, 1
  s_cbranch_scc0 W_46
WD_47:
  v_and_b32 v10, 7, v0
  v_lshlrev_b32 v10, 5, v10
  v_add_u32 v11, 132352, v10
  ds_read_b128 v[20:23], v11
  ds_read_b128 v[24:27], v11 offset:16
  s_lshl_b32 s10, s68, 8
  s_add_u32 s10, s10, 196608
  s_lshl_b32 s11, s67, 5
  s_add_u32 s11, s11, s10
  v_mov_b32 v11, 0
  s_waitcnt lgkmcnt(0)
  v_max_f32_dpp v20, v20, v20 quad_perm:[1,0,3,2] row_mask:0xf bank_mask:0xf
  v_max_f32_dpp v21, v21, v21 quad_perm:[1,0,3,2] row_mask:0xf bank_mask:0xf
  v_max_f32_dpp v22, v22, v22 quad_perm:[1,0,3,2] row_mask:0xf bank_mask:0xf
  v_max_f32_dpp v23, v23, v23 quad_perm:[1,0,3,2] row_mask:0xf bank_mask:0xf
  v_max_f32_dpp v20, v20, v20 quad_perm:[2,3,0,1] row_mask:0xf bank_mask:0xf
  v_max_f32_dpp v21, v21, v21 quad_perm:[2,3,0,1] row_mask:0xf bank_mask:0xf
  v_max_f32_dpp v22, v22, v22 quad_perm:[2,3,0,1] row_mask:0xf bank_mask:0xf
  v_max_f32_dpp v23, v23, v23 quad_perm:[2,3,0,1] row_mask:0xf bank_mask:0xf
  v_max_f32_dpp v20, v20, v20 row_half_mirror row_mask:0xf bank_mask:0xf
  v_max_f32_dpp v21, v21, v21 row_half_mirror row_mask:0xf bank_mask:0xf
  v_max_f32_dpp v22, v22, v22 row_half_mirror row_mask:0xf bank_mask:0xf
  v_max_f32_dpp v23, v23, v23 row_half_mirror row_mask:0xf bank_mask:0xf
  v_add_f32_dpp v24, v24, v24 quad_perm:[1,0,3,2] row_mask:0xf bank_mask:0xf
  v_add_f32_dpp v25, v25, v25 quad_perm:[1,0,3,2] row_mask:0xf bank_mask:0xf
  v_add_f32_dpp v26, v26, v26 quad_perm:[1,0,3,2] row_mask:0xf bank_mask:0xf
  v_add_f32_dpp v27, v27, v27 quad_perm:[1,0,3,2] row_mask:0xf bank_mask:0xf
  v_add_f32_dpp v24, v24, v24 quad_perm:[2,3,0,1] row_mask:0xf bank_mask:0xf
  v_add_f32_dpp v25, v25, v25 quad_perm:[2,3,0,1] row_mask:0xf bank_mask:0xf
  v_add_f32_dpp v26, v26, v26 quad_perm:[2,3,0,1] row_mask:0xf bank_mask:0xf
  v_add_f32_dpp v27, v27, v27 quad_perm:[2,3,0,1] row_mask:0xf bank_mask:0xf
  v_add_f32_dpp v24, v24, v24 row_half_mirror row_mask:0xf bank_mask:0xf
  v_add_f32_dpp v25, v25, v25 row_half_mirror row_mask:0xf bank_mask:0xf
  v_add_f32_dpp v26, v26, v26 row_half_mirror row_mask:0xf bank_mask:0xf
  v_add_f32_dpp v27, v27, v27 row_half_mirror row_mask:0xf bank_mask:0xf
  v_or_b32 v20, s60, v20
  v_or_b32 v21, s61, v21
  v_or_b32 v22, s62, v22
  v_or_b32 v23, s63, v23
  v_add_u32 v24, 0x80, v24
  v_add_u32 v25, 0x80, v25
  v_add_u32 v26, 0x80, v26
  v_add_u32 v27, 0x80, v27
  v_and_b32 v24, 0xffffff00, v24
  v_and_b32 v25, 0xffffff00, v25
  v_and_b32 v26, 0xffffff00, v26
  v_and_b32 v27, 0xffffff00, v27
  v_or_b32 v24, s60, v24
  v_or_b32 v25, s61, v25
  v_or_b32 v26, s62, v26
  v_or_b32 v27, s63, v27
  s_mov_b64 exec, 1
  buffer_store_dwordx4 v[20:23], v11, s[52:55], s11 offen sc1
  buffer_store_dwordx4 v[24:27], v11, s[52:55], s11 offen offset:16 sc1
  s_mov_b64 exec, -1
NOST_45:
  s_cmp_ge_u32 s5, 24
  s_cbranch_scc1 L_PW
  s_sub_u32 s10, s5, 8
  s_cmp_ge_u32 s10, 7
  s_cbranch_scc1 L_DONE
L_PW:
  s_cmp_eq_u32 s8, 1
  s_cbranch_scc1 L_PW2
  s_mov_b32 s69, 400000
W_48:
  ds_read_b32 v4, v1 offset:128
  s_waitcnt lgkmcnt(0)
  v_cmp_gt_u32 vcc, 1, v4
  s_nop 0
  s_cbranch_vccz WD_49
  s_sleep 1
  s_sub_u32 s69, s69, 1
  s_cbranch_scc0 W_48
WD_49:
  s_mov_b32 s8, 2
L_TW:
  s_cmp_ge_u32 s5, 24
  s_cbranch_scc1 L_TW2
  s_sub_u32 s10, s5, 8
  s_mul_i32 s12, s4, 7
  s_add_u32 s12, s12, s10
  s_cmp_ge_u32 s6, 4
  s_cselect_b32 s14, s30, s28
  s_cselect_b32 s15, s31, s29
  s_mov_b32 s44, s14
  s_mov_b32 s45, s15
  s_mov_b32 s46, 0x1c0000
  s_mov_b32 s47, 0x20000
  v_lshrrev_b32 v10, 4, v0
  v_lshlrev_b32 v10, 5, v10
  v_bfe_u32 v11, v0, 2, 2
  v_lshl_add_u32 v10, v11, 1, v10
  v_mul_u32_u24 v10, 3584, v10
  v_and_b32 v11, 3, v0
  v_lshl_add_u32 v10, v11, 4, v10
  s_and_b32 s10, s6, 3
  s_mul_i32 s10, s10, 458752
  s_lshl_b32 s11, s12, 6
  s_add_u32 s10, s10, s11
  buffer_load_dwordx4 v[64:67], v10, s[44:47], s10 offen nt
  s_add_u32 s11, s10, 28672
  buffer_load_dwordx4 v[68:71], v10, s[44:47], s11 offen nt
  s_add_u32 s11, s10, 57344
  buffer_load_dwordx4 v[72:75], v10, s[44:47], s11 offen nt
  s_add_u32 s11, s10, 86016
  buffer_load_dwordx4 v[76:79], v10, s[44:47], s11 offen nt
  s_add_u32 s11, s10, 3584
  buffer_load_dwordx4 v[80:83], v10, s[44:47], s11 offen nt
  s_add_u32 s11, s10, 32256
  buffer_load_dwordx4 v[84:87], v10, s[44:47], s11 offen nt
  s_add_u32 s11, s10, 60928
  buffer_load_dwordx4 v[88:91], v10, s[44:47], s11 offen nt
  s_add_u32 s11, s10, 89600
  buffer_load_dwordx4 v[92:95], v10, s[44:47], s11 offen nt
  s_cmp_lt_u32 s6, 4
  s_cbranch_scc1 L_TWE
  s_mov_b32 s48, s32
  s_mov_b32 s49, s33
  s_mov_b32 s50, 0x1c0000
  s_mov_b32 s51, 0x20000
  v_lshrrev_b32 v10, 4, v0
  v_lshlrev_b32 v10, 11, v10
  v_and_b32 v11, 15, v0
  v_lshl_add_u32 v10, v11, 4, v10
  s_lshl_b32 s10, s12, 15
  s_and_b32 s11, s6, 3
  s_lshl_b32 s11, s11, 8
  s_add_u32 s10, s10, s11
  buffer_load_dwordx4 v[96:99], v10, s[48:51], s10 offen nt
  s_add_u32 s11, s10, 8192
  buffer_load_dwordx4 v[100:103], v10, s[48:51], s11 offen nt
  s_add_u32 s11, s10, 16384
  buffer_load_dwordx4 v[104:107], v10, s[48:51], s11 offen nt
  s_add_u32 s11, s10, 24576
  buffer_load_dwordx4 v[108:111], v10, s[48:51], s11 offen nt
  s_add_u32 s11, s10, 1024
  buffer_load_dwordx4 v[112:115], v10, s[48:51], s11 offen nt
  s_add_u32 s11, s10, 9216
  buffer_load_dwordx4 v[116:119], v10, s[48:51], s11 offen nt
  s_add_u32 s11, s10, 17408
  buffer_load_dwordx4 v[120:123], v10, s[48:51], s11 offen nt
  s_add_u32 s11, s10, 25600
  buffer_load_dwordx4 v[124:127], v10, s[48:51], s11 offen nt
  s_branch L_TWE
L_TW2:
  s_mov_b32 s44, s24
  s_mov_b32 s45, s25
  s_mov_b32 s46, 0x400000
  s_mov_b32 s47, 0x20000
  v_lshrrev_b32 v10, 3, v0
  v_lshlrev_b32 v10, 11, v10
  v_and_b32 v11, 7, v0
  v_lshl_add_u32 v10, v11, 4, v10
  s_lshl_b32 s10, s4, 9
  s_lshl_b32 s11, s6, 4
  s_add_u32 s10, s10, s11
  s_lshl_b32 s10, s10, 10
  s_sub_u32 s11, s5, 24
  s_lshl_b32 s11, s11, 7
  s_add_u32 s10, s10, s11
  buffer_load_dwordx4 v[64:67], v10, s[44:47], s10 offen nt
  s_add_u32 s11, s10, 131072
  buffer_load_dwordx4 v[68:71], v10, s[44:47], s11 offen nt
  s_add_u32 s11, s10, 262144
  buffer_load_dwordx4 v[72:75], v10, s[44:47], s11 offen nt
  s_add_u32 s11, s10, 393216
  buffer_load_dwordx4 v[76:79], v10, s[44:47], s11 offen nt
  s_add_u32 s11, s10, 1024
  buffer_load_dwordx4 v[80:83], v10, s[44:47], s11 offen nt
  s_add_u32 s11, s10, 132096
  buffer_load_dwordx4 v[84:87], v10, s[44:47], s11 offen nt
  s_add_u32 s11, s10, 263168
  buffer_load_dwordx4 v[88:91], v10, s[44:47], s11 offen nt
  s_add_u32 s11, s10, 394240
  buffer_load_dwordx4 v[92:95], v10, s[44:47], s11 offen nt
L_TWE:
  s_cmp_eq_u32 s8, 2
  s_mov_b32 s8, 1
  s_cbranch_scc0 L_WQ
L_PW2:
  s_cmp_ge_u32 s5, 24
  s_cbranch_scc1 L_PT2
  v_lshlrev_b32 v10, 4, v0
  s_lshr_b32 s11, s6, 1
  s_lshl_b32 s10, s11, 11
  s_add_u32 s10, s10, 69632
  s_and_b32 s12, s6, 1
  s_mul_i32 s13, s12, 24576
  s_add_u32 s10, s10, s13
  s_add_u32 s13, s10, 12288
  s_lshl_b32 s11, s11, 12
  s_lshl_b32 s12, s12, 11
  s_add_u32 s11, s11, s12
  s_add_u32 s11, s11, 137216
  v_lshlrev_b32 v12, 3, v0
  v_add_u32 v12, s11, v12
  s_mov_b32 s69, 400000
  s_mov_b64 s[16:17], exec
  s_mov_b64 s[18:19], exec
  s_mov_b64 s[20:21], exec
  s_mov_b64 s[22:23], exec
G_50:
  s_mov_b64 exec, s[16:17]
  buffer_load_dwordx4 v[16:19], v10, s[52:55], s10 offen offset:0 sc1
  s_mov_b64 exec, s[18:19]
  buffer_load_dwordx4 v[20:23], v10, s[52:55], s10 offen offset:1024 sc1
  s_mov_b64 exec, s[20:21]
  buffer_load_dwordx4 v[24:27], v10, s[52:55], s13 offen offset:0 sc1
  s_mov_b64 exec, s[22:23]
  buffer_load_dwordx4 v[28:31], v10, s[52:55], s13 offen offset:1024 sc1
  s_waitcnt vmcnt(0)
  s_mov_b64 exec, s[16:17]
  s_cbranch_execz GS_52
  v_perm_b32 v13, v17, v16, s26
  v_perm_b32 v14, v19, v18, s27
  v_or_b32 v13, v13, v14
  v_cmp_ne_u32 s[16:17], s0, v13
GS_52:
  s_mov_b64 exec, s[18:19]
  s_cbranch_execz GS_53
  v_perm_b32 v13, v21, v20, s26
  v_perm_b32 v14, v23, v22, s27
  v_or_b32 v13, v13, v14
  v_cmp_ne_u32 s[18:19], s0, v13
GS_53:
  s_mov_b64 exec, s[20:21]
  s_cbranch_execz GS_54
  v_perm_b32 v13, v25, v24, s26
  v_perm_b32 v14, v27, v26, s27
  v_or_b32 v13, v13, v14
  v_cmp_ne_u32 s[20:21], s0, v13
GS_54:
  s_mov_b64 exec, s[22:23]
  s_cbranch_execz GS_55
  v_perm_b32 v13, v29, v28, s26
  v_perm_b32 v14, v31, v30, s27
  v_or_b32 v13, v13, v14
  v_cmp_ne_u32 s[22:23], s0, v13
GS_55:
  s_or_b64 vcc, s[16:17], s[18:19]
  s_or_b64 vcc, vcc, s[20:21]
  s_or_b64 vcc, vcc, s[22:23]
  s_cbranch_scc0 GD_51
  s_sleep 2
  s_sub_u32 s69, s69, 1
  s_cbranch_scc0 G_50
GD_51:
  s_mov_b64 exec, -1
  v_and_b32 v16, s1, v16
  v_and_b32 v17, s1, v17
  v_and_b32 v18, s1, v18
  v_and_b32 v19, s1, v19
  v_and_b32 v20, s1, v20
  v_and_b32 v21, s1, v21
  v_and_b32 v22, s1, v22
  v_and_b32 v23, s1, v23
  v_and_b32 v24, s1, v24
  v_and_b32 v25, s1, v25
  v_and_b32 v26, s1, v26
  v_and_b32 v27, s1, v27
  v_and_b32 v28, s1, v28
  v_and_b32 v29, s1, v29
  v_and_b32 v30, s1, v30
  v_and_b32 v31, s1, v31
  s_lshr_b32 s11, s6, 1
  s_cmp_lg_u32 s11, 2
  s_cbranch_scc1 NCB_56
  v_add_f32 v16, 1.0, v16
  v_add_f32 v17, 1.0, v17
  v_add_f32 v18, 1.0, v18
  v_add_f32 v19, 1.0, v19
  v_add_f32 v20, 1.0, v20
  v_add_f32 v21, 1.0, v21
  v_add_f32 v22, 1.0, v22
  v_add_f32 v23, 1.0, v23
  v_add_f32 v24, 1.0, v24
  v_add_f32 v25, 1.0, v25
  v_add_f32 v26, 1.0, v26
  v_add_f32 v27, 1.0, v27
  v_add_f32 v28, 1.0, v28
  v_add_f32 v29, 1.0, v29
  v_add_f32 v30, 1.0, v30
  v_add_f32 v31, 1.0, v31
NCB_56:
  v_cvt_pk_bf16_f32 v32, v16, v17
  v_cvt_pk_bf16_f32 v33, v18, v19
  v_cvt_pk_bf16_f32 v34, v20, v21
  v_cvt_pk_bf16_f32 v35, v22, v23
  v_cvt_pk_bf16_f32 v36, v24, v25
  v_cvt_pk_bf16_f32 v37, v26, v27
  v_cvt_pk_bf16_f32 v38, v28, v29
  v_cvt_pk_bf16_f32 v39, v30, v31
  ds_write_b64 v12, v[32:33] offset:0
  ds_write_b64 v12, v[34:35] offset:512
  ds_write_b64 v12, v[36:37] offset:1024
  ds_write_b64 v12, v[38:39] offset:1536
  s_waitcnt lgkmcnt(0)
  s_mov_b64 exec, 1
  ds_add_u32 v3, v2 offset:28
  s_mov_b64 exec, -1
  s_branch L_T3H
L_PT2:
  s_cmp_ge_u32 s6, 4
  s_cbranch_scc1 L_T2H
  v_and_b32 v10, 7, v0
  v_lshlrev_b32 v11, 4, v10
  v_lshlrev_b32 v10, 5, v10
  s_lshl_b32 s10, s6, 3
  s_add_u32 s10, s10, s4
  s_lshl_b32 s10, s10, 8
  s_add_u32 s10, s10, 196608
  s_lshl_b32 s11, s6, 7
  s_add_u32 s11, s11, 132608
  v_add_u32 v12, s11, v11
  s_mov_b32 exec_lo, 0xff
  s_mov_b32 exec_hi, 0x0
  s_mov_b32 s69, 400000
  s_mov_b64 s[16:17], exec
  s_mov_b64 s[18:19], exec
G_57:
  s_mov_b64 exec, s[16:17]
  buffer_load_dwordx4 v[20:23], v10, s[52:55], s10 offen offset:0 sc1
  s_mov_b64 exec, s[18:19]
  buffer_load_dwordx4 v[24:27], v10, s[52:55], s10 offen offset:16 sc1
  s_waitcnt vmcnt(0)
  s_mov_b64 exec, s[16:17]
  s_cbranch_execz GS_59
  v_perm_b32 v13, v21, v20, s26
  v_perm_b32 v14, v23, v22, s27
  v_or_b32 v13, v13, v14
  v_cmp_ne_u32 s[16:17], s0, v13
GS_59:
  s_mov_b64 exec, s[18:19]
  s_cbranch_execz GS_60
  v_perm_b32 v13, v25, v24, s26
  v_perm_b32 v14, v27, v26, s27
  v_or_b32 v13, v13, v14
  v_cmp_ne_u32 s[18:19], s0, v13
GS_60:
  s_nop 0
  s_or_b64 vcc, s[16:17], s[18:19]
  s_cbranch_scc0 GD_58
  s_sleep 1
  s_sub_u32 s69, s69, 1
  s_cbranch_scc0 G_57
GD_58:
  s_mov_b32 exec_lo, 0xff
  s_mov_b32 exec_hi, 0x0
  v_and_b32 v20, s1, v20
  v_and_b32 v21, s1, v21
  v_and_b32 v22, s1, v22
  v_and_b32 v23, s1, v23
  v_and_b32 v24, s1, v24
  v_and_b32 v25, s1, v25
  v_and_b32 v26, s1, v26
  v_and_b32 v27, s1, v27
  v_mov_b32 v28, v20
  v_mov_b32 v29, v21
  v_mov_b32 v30, v22
  v_mov_b32 v31, v23
  v_max_f32_dpp v28, v28, v28 quad_perm:[1,0,3,2] row_mask:0xf bank_mask:0xf
  v_max_f32_dpp v29, v29, v29 quad_perm:[1,0,3,2] row_mask:0xf bank_mask:0xf
  v_max_f32_dpp v30, v30, v30 quad_perm:[1,0,3,2] row_mask:0xf bank_mask:0xf
  v_max_f32_dpp v31, v31, v31 quad_perm:[1,0,3,2] row_mask:0xf bank_mask:0xf
  v_max_f32_dpp v28, v28, v28 quad_perm:[2,3,0,1] row_mask:0xf bank_mask:0xf
  v_max_f32_dpp v29, v29, v29 quad_perm:[2,3,0,1] row_mask:0xf bank_mask:0xf
  v_max_f32_dpp v30, v30, v30 quad_perm:[2,3,0,1] row_mask:0xf bank_mask:0xf
  v_max_f32_dpp v31, v31, v31 quad_perm:[2,3,0,1] row_mask:0xf bank_mask:0xf
  v_max_f32_dpp v28, v28, v28 row_half_mirror row_mask:0xf bank_mask:0xf
  v_max_f32_dpp v29, v29, v29 row_half_mirror row_mask:0xf bank_mask:0xf
  v_max_f32_dpp v30, v30, v30 row_half_mirror row_mask:0xf bank_mask:0xf
  v_max_f32_dpp v31, v31, v31 row_half_mirror row_mask:0xf bank_mask:0xf
  v_sub_f32 v20, v20, v28
  v_sub_f32 v21, v21, v29
  v_sub_f32 v22, v22, v30
  v_sub_f32 v23, v23, v31
  v_mul_f32 v20, 0x3fb8aa3b, v20
  v_mul_f32 v21, 0x3fb8aa3b, v21
  v_mul_f32 v22, 0x3fb8aa3b, v22
  v_mul_f32 v23, 0x3fb8aa3b, v23
  v_exp_f32 v20, v20
  v_exp_f32 v21, v21
  v_exp_f32 v22, v22
  v_exp_f32 v23, v23
  v_mul_f32 v24, v24, v20
  v_mul_f32 v25, v25, v21
  v_mul_f32 v26, v26, v22
  v_mul_f32 v27, v27, v23
  v_add_f32_dpp v24, v24, v24 quad_perm:[1,0,3,2] row_mask:0xf bank_mask:0xf
  v_add_f32_dpp v25, v25, v25 quad_perm:[1,0,3,2] row_mask:0xf bank_mask:0xf
  v_add_f32_dpp v26, v26, v26 quad_perm:[1,0,3,2] row_mask:0xf bank_mask:0xf
  v_add_f32_dpp v27, v27, v27 quad_perm:[1,0,3,2] row_mask:0xf bank_mask:0xf
  v_add_f32_dpp v24, v24, v24 quad_perm:[2,3,0,1] row_mask:0xf bank_mask:0xf
  v_add_f32_dpp v25, v25, v25 quad_perm:[2,3,0,1] row_mask:0xf bank_mask:0xf
  v_add_f32_dpp v26, v26, v26 quad_perm:[2,3,0,1] row_mask:0xf bank_mask:0xf
  v_add_f32_dpp v27, v27, v27 quad_perm:[2,3,0,1] row_mask:0xf bank_mask:0xf
  v_add_f32_dpp v24, v24, v24 row_half_mirror row_mask:0xf bank_mask:0xf
  v_add_f32_dpp v25, v25, v25 row_half_mirror row_mask:0xf bank_mask:0xf
  v_add_f32_dpp v26, v26, v26 row_half_mirror row_mask:0xf bank_mask:0xf
  v_add_f32_dpp v27, v27, v27 row_half_mirror row_mask:0xf bank_mask:0xf
  v_rcp_f32 v24, v24
  v_rcp_f32 v25, v25
  v_rcp_f32 v26, v26
  v_rcp_f32 v27, v27
  v_mul_f32 v20, v20, v24
  v_mul_f32 v21, v21, v25
  v_mul_f32 v22, v22, v26
  v_mul_f32 v23, v23, v27
  ds_write_b128 v12, v[20:23]
  s_mov_b64 exec, -1
  s_waitcnt lgkmcnt(0)
  s_mov_b64 exec, 1
  ds_add_u32 v3, v2 offset:28
  s_mov_b64 exec, -1
L_T2H:
  v_and_b32 v10, 3, v0
  v_lshlrev_b32 v11, 10, v10
  v_lshrrev_b32 v12, 4, v0
  v_lshl_add_u32 v11, v12, 5, v11
  v_bfe_u32 v12, v0, 2, 1
  v_lshl_add_u32 v11, v12, 4, v11
  s_lshl_b32 s10, s6, 7
  s_add_u32 s10, s10, 0
  v_add_u32 v11, s10, v11
  v_bfe_u32 v12, v0, 4, 1
  v_lshlrev_b32 v12, 4, v12
  v_lshrrev_b32 v13, 5, v0
  v_add_u32 v12, v12, v13
  s_lshl_b32 s10, s6, 1
  v_add_u32 v12, s10, v12
  v_mul_u32_u24 v12, 528, v12
  v_lshl_add_u32 v12, v10, 4, v12
  v_add_u32 v12, 32768, v12
  v_and_b32 v13, 7, v0
  v_mul_u32_u24 v13, 528, v13
  v_lshrrev_b32 v14, 3, v0
  v_lshl_add_u32 v13, v14, 6, v13
  s_and_b32 s10, s6, 3
  s_lshr_b32 s15, s6, 2
  s_lshl_b32 s11, s10, 4
  s_mul_i32 s12, s15, 8448
  s_add_u32 s11, s11, s12
  s_add_u32 s11, s11, 32768
  v_add_u32 v13, s11, v13
  v_lshlrev_b32 v14, 4, v14
  s_lshl_b32 s11, s4, 2
  s_add_u32 s11, s11, s10
  s_lshl_b32 s11, s11, 11
  s_sub_u32 s12, s5, 24
  s_lshl_b32 s12, s12, 8
  s_add_u32 s11, s11, s12
  s_lshl_b32 s12, s15, 7
  s_add_u32 s11, s11, s12
  s_add_u32 s12, s11, 786432
  v_mov_b32 v15, 0xffffff00
  s_waitcnt vmcnt(0)
  v_perm_b32 v96, v68, v64, s71
  v_perm_b32 v97, v76, v72, s71
  v_perm_b32 v98, v84, v80, s71
  v_perm_b32 v99, v92, v88, s71
  v_perm_b32 v100, v68, v64, s72
  v_perm_b32 v101, v76, v72, s72
  v_perm_b32 v102, v84, v80, s72
  v_perm_b32 v103, v92, v88, s72
  v_perm_b32 v104, v69, v65, s71
  v_perm_b32 v105, v77, v73, s71
  v_perm_b32 v106, v85, v81, s71
  v_perm_b32 v107, v93, v89, s71
  v_perm_b32 v108, v69, v65, s72
  v_perm_b32 v109, v77, v73, s72
  v_perm_b32 v110, v85, v81, s72
  v_perm_b32 v111, v93, v89, s72
  v_perm_b32 v112, v70, v66, s71
  v_perm_b32 v113, v78, v74, s71
  v_perm_b32 v114, v86, v82, s71
  v_perm_b32 v115, v94, v90, s71
  v_perm_b32 v116, v70, v66, s72
  v_perm_b32 v117, v78, v74, s72
  v_perm_b32 v118, v86, v82, s72
  v_perm_b32 v119, v94, v90, s72
  v_perm_b32 v120, v71, v67, s71
  v_perm_b32 v121, v79, v75, s71
  v_perm_b32 v122, v87, v83, s71
  v_perm_b32 v123, v95, v91, s71
  v_perm_b32 v124, v71, v67, s72
  v_perm_b32 v125, v79, v75, s72
  v_perm_b32 v126, v87, v83, s72
  v_perm_b32 v127, v95, v91, s72
  s_waitcnt lgkmcnt(0)
  s_barrier
  ds_read_b128 v[24:27], v11
  s_waitcnt lgkmcnt(0)
  v_mfma_f32_16x16x32_bf16 v[32:35], v[96:99], v[24:27], 0
  v_mfma_f32_16x16x32_bf16 v[36:39], v[100:103], v[24:27], 0
  v_mfma_f32_16x16x32_bf16 v[40:43], v[104:107], v[24:27], 0
  v_mfma_f32_16x16x32_bf16 v[44:47], v[108:111], v[24:27], 0
  v_mfma_f32_16x16x32_bf16 v[48:51], v[112:115], v[24:27], 0
  v_mfma_f32_16x16x32_bf16 v[52:55], v[116:119], v[24:27], 0
  v_mfma_f32_16x16x32_bf16 v[56:59], v[120:123], v[24:27], 0
  v_mfma_f32_16x16x32_bf16 v[60:63], v[124:127], v[24:27], 0
  s_mov_b32 exec_lo, 0xf000f
  s_mov_b32 exec_hi, 0xf000f0
  ds_write_b128 v12, v[32:35] offset:0
  ds_write_b128 v12, v[36:39] offset:64
  ds_write_b128 v12, v[40:43] offset:128
  ds_write_b128 v12, v[44:47] offset:192
  ds_write_b128 v12, v[48:51] offset:256
  ds_write_b128 v12, v[52:55] offset:320
  ds_write_b128 v12, v[56:59] offset:384
  ds_write_b128 v12, v[60:63] offset:448
  s_mov_b64 exec, -1
  s_waitcnt lgkmcnt(0)
  s_barrier
  ds_read_b128 v[16:19], v13 offset:0
  ds_read_b128 v[20:23], v13 offset:4224
  s_waitcnt lgkmcnt(0)
  v_pk_add_f32 v[16:17], v[16:17], v[20:21]
  v_pk_add_f32 v[18:19], v[18:19], v[22:23]
  s_nop 0
  v_add_f32_dpp v16, v16, v16 quad_perm:[1,0,3,2] row_mask:0xf bank_mask:0xf
  v_add_f32_dpp v17, v17, v17 quad_perm:[1,0,3,2] row_mask:0xf bank_mask:0xf
  v_add_f32_dpp v18, v18, v18 quad_perm:[1,0,3,2] row_mask:0xf bank_mask:0xf
  v_add_f32_dpp v19, v19, v19 quad_perm:[1,0,3,2] row_mask:0xf bank_mask:0xf
  v_add_f32_dpp v16, v16, v16 quad_perm:[2,3,0,1] row_mask:0xf bank_mask:0xf
  v_add_f32_dpp v17, v17, v17 quad_perm:[2,3,0,1] row_mask:0xf bank_mask:0xf
  v_add_f32_dpp v18, v18, v18 quad_perm:[2,3,0,1] row_mask:0xf bank_mask:0xf
  v_add_f32_dpp v19, v19, v19 quad_perm:[2,3,0,1] row_mask:0xf bank_mask:0xf
  v_add_f32_dpp v16, v16, v16 row_half_mirror row_mask:0xf bank_mask:0xf
  v_add_f32_dpp v17, v17, v17 row_half_mirror row_mask:0xf bank_mask:0xf
  v_add_f32_dpp v18, v18, v18 row_half_mirror row_mask:0xf bank_mask:0xf
  v_add_f32_dpp v19, v19, v19 row_half_mirror row_mask:0xf bank_mask:0xf
  v_add_u32 v16, 0x80, v16
  v_add_u32 v17, 0x80, v17
  v_add_u32 v18, 0x80, v18
  v_add_u32 v19, 0x80, v19
  v_and_or_b32 v16, v16, v15, s60
  v_and_or_b32 v17, v17, v15, s61
  v_and_or_b32 v18, v18, v15, s62
  v_and_or_b32 v19, v19, v15, s63
  s_mov_b32 exec_lo, 0x1010101
  s_mov_b32 exec_hi, 0x1010101
  buffer_store_dwordx4 v[16:19], v14, s[52:55], s12 offen sc1
  s_mov_b64 exec, -1
  s_branch L_DONE
L_TAIL:
  s_cmp_ge_u32 s5, 24
  s_cbranch_scc1 L_T2S
  s_sub_u32 s10, s5, 8
  s_cmp_ge_u32 s10, 7
  s_cbranch_scc1 L_DONE
  s_branch L_T3S
L_T2S:
  s_lshr_b32 s12, s6, 1
  s_and_b32 s13, s6, 1
  v_lshlrev_b32 v10, 4, v0
  s_lshl_b32 s10, s4, 2
  s_add_u32 s10, s10, s12
  s_lshl_b32 s10, s10, 14
  s_lshl_b32 s11, s13, 10
  s_add_u32 s10, s10, s11
  s_add_u32 s10, s10, 262144
  s_add_u32 s11, s10, 4096
  s_add_u32 s14, s10, 8192
  s_add_u32 s15, s10, 12288
  s_lshl_b32 s78, s12, 10
  s_lshl_b32 s79, s13, 9
  s_add_u32 s78, s78, s79
  s_add_u32 s78, s78, 0
  v_lshlrev_b32 v12, 3, v0
  v_add_u32 v12, s78, v12
  s_lshl_b32 s78, s12, 7
  s_add_u32 s78, s78, 132608
  v_mov_b32 v13, s78
  v_lshlrev_b32 v54, 11, v0
  s_mov_b32 s69, 400000
  s_mov_b32 exec_lo, 0xff
  s_mov_b32 exec_hi, 0x0
PP_61:
  buffer_load_dwordx4 v[16:19], v54, s[52:55], s10 offen sc1
  s_waitcnt vmcnt(0)
  v_perm_b32 v52, v17, v16, s26
  v_perm_b32 v53, v19, v18, s27
  v_or_b32 v52, v52, v53
  v_cmp_eq_u32 vcc, s0, v52
  s_nop 0
  s_bcnt1_i32_b64 s7, vcc
  s_cmp_ge_u32 s7, 6
  s_cbranch_scc1 PD_62
  s_sleep 2
  s_sub_u32 s69, s69, 1
  s_cbranch_scc0 PP_61
PD_62:
  s_mov_b64 exec, -1
  s_mov_b32 s69, 400000
  s_mov_b64 s[16:17], exec
  s_mov_b64 s[18:19], exec
  s_mov_b64 s[20:21], exec
  s_mov_b64 s[22:23], exec
  s_mov_b64 s[28:29], exec
  s_mov_b64 s[30:31], exec
  s_mov_b64 s[32:33], exec
  s_mov_b64 s[34:35], exec
G_63:
  s_mov_b64 exec, s[16:17]
  buffer_load_dwordx4 v[16:19], v10, s[52:55], s10 offen offset:0 sc1
  s_mov_b64 exec, s[18:19]
  buffer_load_dwordx4 v[20:23], v10, s[52:55], s10 offen offset:2048 sc1
  s_mov_b64 exec, s[20:21]
  buffer_load_dwordx4 v[24:27], v10, s[52:55], s11 offen offset:0 sc1
  s_mov_b64 exec, s[22:23]
  buffer_load_dwordx4 v[28:31], v10, s[52:55], s11 offen offset:2048 sc1
  s_mov_b64 exec, s[28:29]
  buffer_load_dwordx4 v[32:35], v10, s[52:55], s14 offen offset:0 sc1
  s_mov_b64 exec, s[30:31]
  buffer_load_dwordx4 v[36:39], v10, s[52:55], s14 offen offset:2048 sc1
  s_mov_b64 exec, s[32:33]
  buffer_load_dwordx4 v[40:43], v10, s[52:55], s15 offen offset:0 sc1
  s_mov_b64 exec, s[34:35]
  buffer_load_dwordx4 v[44:47], v10, s[52:55], s15 offen offset:2048 sc1
  s_waitcnt vmcnt(0)
  s_mov_b64 exec, s[16:17]
  s_cbranch_execz GS_65
  v_perm_b32 v14, v17, v16, s26
  v_perm_b32 v15, v19, v18, s27
  v_or_b32 v14, v14, v15
  v_cmp_ne_u32 s[16:17], s0, v14
GS_65:
  s_mov_b64 exec, s[18:19]
  s_cbranch_execz GS_66
  v_perm_b32 v14, v21, v20, s26
  v_perm_b32 v15, v23, v22, s27
  v_or_b32 v14, v14, v15
  v_cmp_ne_u32 s[18:19], s0, v14
GS_66:
  s_mov_b64 exec, s[20:21]
  s_cbranch_execz GS_67
  v_perm_b32 v14, v25, v24, s26
  v_perm_b32 v15, v27, v26, s27
  v_or_b32 v14, v14, v15
  v_cmp_ne_u32 s[20:21], s0, v14
GS_67:
  s_mov_b64 exec, s[22:23]
  s_cbranch_execz GS_68
  v_perm_b32 v14, v29, v28, s26
  v_perm_b32 v15, v31, v30, s27
  v_or_b32 v14, v14, v15
  v_cmp_ne_u32 s[22:23], s0, v14
GS_68:
  s_mov_b64 exec, s[28:29]
  s_cbranch_execz GS_69
  v_perm_b32 v14, v33, v32, s26
  v_perm_b32 v15, v35, v34, s27
  v_or_b32 v14, v14, v15
  v_cmp_ne_u32 s[28:29], s0, v14
GS_69:
  s_mov_b64 exec, s[30:31]
  s_cbranch_execz GS_70
  v_perm_b32 v14, v37, v36, s26
  v_perm_b32 v15, v39, v38, s27
  v_or_b32 v14, v14, v15
  v_cmp_ne_u32 s[30:31], s0, v14
GS_70:
  s_mov_b64 exec, s[32:33]
  s_cbranch_execz GS_71
  v_perm_b32 v14, v41, v40, s26
  v_perm_b32 v15, v43, v42, s27
  v_or_b32 v14, v14, v15
  v_cmp_ne_u32 s[32:33], s0, v14
GS_71:
  s_mov_b64 exec, s[34:35]
  s_cbranch_execz GS_72
  v_perm_b32 v14, v45, v44, s26
  v_perm_b32 v15, v47, v46, s27
  v_or_b32 v14, v14, v15
  v_cmp_ne_u32 s[34:35], s0, v14
GS_72:
  s_or_b64 vcc, s[16:17], s[18:19]
  s_or_b64 vcc, vcc, s[20:21]
  s_or_b64 vcc, vcc, s[22:23]
  s_or_b64 vcc, vcc, s[28:29]
  s_or_b64 vcc, vcc, s[30:31]
  s_or_b64 vcc, vcc, s[32:33]
  s_or_b64 vcc, vcc, s[34:35]
  s_cbranch_scc0 GD_64
  s_sub_u32 s69, s69, 1
  s_cbranch_scc0 G_63
GD_64:
  s_mov_b64 exec, -1
  v_and_b32 v16, s1, v16
  v_and_b32 v17, s1, v17
  v_and_b32 v18, s1, v18
  v_and_b32 v19, s1, v19
  v_and_b32 v20, s1, v20
  v_and_b32 v21, s1, v21
  v_and_b32 v22, s1, v22
  v_and_b32 v23, s1, v23
  v_and_b32 v24, s1, v24
  v_and_b32 v25, s1, v25
  v_and_b32 v26, s1, v26
  v_and_b32 v27, s1, v27
  v_and_b32 v28, s1, v28
  v_and_b32 v29, s1, v29
  v_and_b32 v30, s1, v30
  v_and_b32 v31, s1, v31
  v_and_b32 v32, s1, v32
  v_and_b32 v33, s1, v33
  v_and_b32 v34, s1, v34
  v_and_b32 v35, s1, v35
  v_and_b32 v36, s1, v36
  v_and_b32 v37, s1, v37
  v_and_b32 v38, s1, v38
  v_and_b32 v39, s1, v39
  v_and_b32 v40, s1, v40
  v_and_b32 v41, s1, v41
  v_and_b32 v42, s1, v42
  v_and_b32 v43, s1, v43
  v_and_b32 v44, s1, v44
  v_and_b32 v45, s1, v45
  v_and_b32 v46, s1, v46
  v_and_b32 v47, s1, v47
  s_mov_b32 s69, 400000
W_73:
  ds_read_b32 v15, v3 offset:28
  s_waitcnt lgkmcnt(0)
  v_cmp_gt_u32 vcc, 4, v15
  s_nop 0
  s_cbranch_vccz WD_74
  s_sub_u32 s69, s69, 1
  s_cbranch_scc0 W_73
WD_74:
  ds_read_b128 v[64:67], v13 offset:0
  ds_read_b128 v[68:71], v13 offset:16
  ds_read_b128 v[72:75], v13 offset:32
  ds_read_b128 v[76:79], v13 offset:48
  ds_read_b128 v[80:83], v13 offset:64
  ds_read_b128 v[84:87], v13 offset:80
  ds_read_b128 v[88:91], v13 offset:96
  ds_read_b128 v[92:95], v13 offset:112
  s_waitcnt lgkmcnt(7)
  v_mul_f32 v48, v64, v16
  v_mul_f32 v49, v65, v17
  v_mul_f32 v50, v66, v18
  v_mul_f32 v51, v67, v19
  s_waitcnt lgkmcnt(6)
  v_fmac_f32 v48, v68, v20
  v_fmac_f32 v49, v69, v21
  v_fmac_f32 v50, v70, v22
  v_fmac_f32 v51, v71, v23
  s_waitcnt lgkmcnt(5)
  v_fmac_f32 v48, v72, v24
  v_fmac_f32 v49, v73, v25
  v_fmac_f32 v50, v74, v26
  v_fmac_f32 v51, v75, v27
  s_waitcnt lgkmcnt(4)
  v_fmac_f32 v48, v76, v28
  v_fmac_f32 v49, v77, v29
  v_fmac_f32 v50, v78, v30
  v_fmac_f32 v51, v79, v31
  s_waitcnt lgkmcnt(3)
  v_fmac_f32 v48, v80, v32
  v_fmac_f32 v49, v81, v33
  v_fmac_f32 v50, v82, v34
  v_fmac_f32 v51, v83, v35
  s_waitcnt lgkmcnt(2)
  v_fmac_f32 v48, v84, v36
  v_fmac_f32 v49, v85, v37
  v_fmac_f32 v50, v86, v38
  v_fmac_f32 v51, v87, v39
  s_waitcnt lgkmcnt(1)
  v_fmac_f32 v48, v88, v40
  v_fmac_f32 v49, v89, v41
  v_fmac_f32 v50, v90, v42
  v_fmac_f32 v51, v91, v43
  s_waitcnt lgkmcnt(0)
  v_fmac_f32 v48, v92, v44
  v_fmac_f32 v49, v93, v45
  v_fmac_f32 v50, v94, v46
  v_fmac_f32 v51, v95, v47
  v_cvt_pk_bf16_f32 v16, v48, v49
  v_cvt_pk_bf16_f32 v17, v50, v51
  ds_write_b64 v12, v[16:17]
L_T2X:
  s_waitcnt lgkmcnt(0)
  s_barrier
  s_branch L_DONE
L_T3H:
  v_and_b32 v10, 3, v0
  v_lshlrev_b32 v11, 10, v10
  v_lshrrev_b32 v12, 2, v0
  v_lshl_add_u32 v11, v12, 4, v11
  s_and_b32 s10, s6, 3
  s_lshl_b32 s11, s10, 8
  s_add_u32 s11, s11, 0
  v_add_u32 v11, s11, v11
  v_lshlrev_b32 v12, 4, v10
  v_lshrrev_b32 v13, 4, v0
  v_mul_u32_u24 v13, 528, v13
  v_add_u32 v12, v12, v13
  s_mul_i32 s11, s6, 2112
  s_add_u32 s11, s11, 32768
  v_add_u32 v12, s11, v12
  v_and_b32 v13, 7, v0
  v_mul_u32_u24 v13, 528, v13
  v_lshrrev_b32 v14, 3, v0
  v_lshl_add_u32 v13, v14, 6, v13
  s_lshl_b32 s11, s10, 4
  s_add_u32 s11, s11, 32768
  v_add_u32 v13, s11, v13
  v_lshlrev_b32 v14, 3, v14
  s_lshl_b32 s11, s10, 6
  s_add_u32 s11, s11, 4352
  v_add_u32 v14, s11, v14
  v_and_b32 v15, 3, v0
  v_lshlrev_b32 v15, 6, v15
  v_lshrrev_b32 v7, 4, v0
  v_lshl_add_u32 v15, v7, 4, v15
  v_add_u32 v15, 4352, v15
  v_and_b32 v8, 3, v0
  v_lshl_add_u32 v8, v7, 2, v8
  v_lshlrev_b32 v8, 4, v8
  s_mul_i32 s12, s4, 7
  s_add_u32 s12, s12, s5
  s_sub_u32 s12, s12, 8
  s_lshl_b32 s12, s12, 8
  s_mul_i32 s11, s10, 114688
  s_add_u32 s12, s12, s11
  s_add_u32 s12, s12, 1048576
  v_mov_b32 v9, 0xffffff00
  s_waitcnt vmcnt(0)
  v_perm_b32 v32, v68, v64, s71
  v_perm_b32 v33, v76, v72, s71
  v_perm_b32 v34, v84, v80, s71
  v_perm_b32 v35, v92, v88, s71
  v_perm_b32 v36, v68, v64, s72
  v_perm_b32 v37, v76, v72, s72
  v_perm_b32 v38, v84, v80, s72
  v_perm_b32 v39, v92, v88, s72
  v_perm_b32 v40, v69, v65, s71
  v_perm_b32 v41, v77, v73, s71
  v_perm_b32 v42, v85, v81, s71
  v_perm_b32 v43, v93, v89, s71
  v_perm_b32 v44, v69, v65, s72
  v_perm_b32 v45, v77, v73, s72
  v_perm_b32 v46, v85, v81, s72
  v_perm_b32 v47, v93, v89, s72
  v_perm_b32 v48, v70, v66, s71
  v_perm_b32 v49, v78, v74, s71
  v_perm_b32 v50, v86, v82, s71
  v_perm_b32 v51, v94, v90, s71
  v_perm_b32 v52, v70, v66, s72
  v_perm_b32 v53, v78, v74, s72
  v_perm_b32 v54, v86, v82, s72
  v_perm_b32 v55, v94, v90, s72
  v_perm_b32 v56, v71, v67, s71
  v_perm_b32 v57, v79, v75, s71
  v_perm_b32 v58, v87, v83, s71
  v_perm_b32 v59, v95, v91, s71
  v_perm_b32 v60, v71, v67, s72
  v_perm_b32 v61, v79, v75, s72
  v_perm_b32 v62, v87, v83, s72
  v_perm_b32 v63, v95, v91, s72
  s_cmp_lt_u32 s6, 4
  s_cbranch_scc1 UP_76
  v_perm_b32 v64, v100, v96, s71
  v_perm_b32 v65, v108, v104, s71
  v_perm_b32 v66, v116, v112, s71
  v_perm_b32 v67, v124, v120, s71
  v_perm_b32 v68, v100, v96, s72
  v_perm_b32 v69, v108, v104, s72
  v_perm_b32 v70, v116, v112, s72
  v_perm_b32 v71, v124, v120, s72
  v_perm_b32 v72, v101, v97, s71
  v_perm_b32 v73, v109, v105, s71
  v_perm_b32 v74, v117, v113, s71
  v_perm_b32 v75, v125, v121, s71
  v_perm_b32 v76, v101, v97, s72
  v_perm_b32 v77, v109, v105, s72
  v_perm_b32 v78, v117, v113, s72
  v_perm_b32 v79, v125, v121, s72
  v_perm_b32 v80, v102, v98, s71
  v_perm_b32 v81, v110, v106, s71
  v_perm_b32 v82, v118, v114, s71
  v_perm_b32 v83, v126, v122, s71
  v_perm_b32 v84, v102, v98, s72
  v_perm_b32 v85, v110, v106, s72
  v_perm_b32 v86, v118, v114, s72
  v_perm_b32 v87, v126, v122, s72
  v_perm_b32 v88, v103, v99, s71
  v_perm_b32 v89, v111, v107, s71
  v_perm_b32 v90, v119, v115, s71
  v_perm_b32 v91, v127, v123, s71
  v_perm_b32 v92, v103, v99, s72
  v_perm_b32 v93, v111, v107, s72
  v_perm_b32 v94, v119, v115, s72
  v_perm_b32 v95, v127, v123, s72
UP_76:
  s_barrier
  s_barrier
  ds_read_b128 v[24:27], v11
  s_waitcnt lgkmcnt(0)
  v_mfma_f32_16x16x32_bf16 v[96:99], v[32:35], v[24:27], 0
  v_mfma_f32_16x16x32_bf16 v[100:103], v[36:39], v[24:27], 0
  v_mfma_f32_16x16x32_bf16 v[104:107], v[40:43], v[24:27], 0
  v_mfma_f32_16x16x32_bf16 v[108:111], v[44:47], v[24:27], 0
  v_mfma_f32_16x16x32_bf16 v[112:115], v[48:51], v[24:27], 0
  v_mfma_f32_16x16x32_bf16 v[116:119], v[52:55], v[24:27], 0
  v_mfma_f32_16x16x32_bf16 v[120:123], v[56:59], v[24:27], 0
  v_mfma_f32_16x16x32_bf16 v[124:127], v[60:63], v[24:27], 0
  s_mov_b64 exec, s[76:77]
  ds_write_b128 v12, v[96:99] offset:0
  ds_write_b128 v12, v[100:103] offset:64
  ds_write_b128 v12, v[104:107] offset:128
  ds_write_b128 v12, v[108:111] offset:192
  ds_write_b128 v12, v[112:115] offset:256
  ds_write_b128 v12, v[116:119] offset:320
  ds_write_b128 v12, v[120:123] offset:384
  ds_write_b128 v12, v[124:127] offset:448
  s_mov_b64 exec, -1
  s_waitcnt lgkmcnt(0)
  s_barrier
  s_cmp_ge_u32 s6, 4
  s_cbranch_scc1 DN_75
  ds_read_b128 v[16:19], v13 offset:0
  ds_read_b128 v[20:23], v13 offset:4224
  ds_read_b128 v[24:27], v13 offset:8448
  ds_read_b128 v[28:31], v13 offset:12672
  s_waitcnt lgkmcnt(0)
  v_pk_add_f32 v[16:17], v[16:17], v[20:21]
  v_pk_add_f32 v[18:19], v[18:19], v[22:23]
  v_pk_add_f32 v[24:25], v[24:25], v[28:29]
  v_pk_add_f32 v[26:27], v[26:27], v[30:31]
  v_add_f32_dpp v16, v16, v16 quad_perm:[1,0,3,2] row_mask:0xf bank_mask:0xf
  v_add_f32_dpp v17, v17, v17 quad_perm:[1,0,3,2] row_mask:0xf bank_mask:0xf
  v_add_f32_dpp v18, v18, v18 quad_perm:[1,0,3,2] row_mask:0xf bank_mask:0xf
  v_add_f32_dpp v19, v19, v19 quad_perm:[1,0,3,2] row_mask:0xf bank_mask:0xf
  v_add_f32_dpp v24, v24, v24 quad_perm:[1,0,3,2] row_mask:0xf bank_mask:0xf
  v_add_f32_dpp v25, v25, v25 quad_perm:[1,0,3,2] row_mask:0xf bank_mask:0xf
  v_add_f32_dpp v26, v26, v26 quad_perm:[1,0,3,2] row_mask:0xf bank_mask:0xf
  v_add_f32_dpp v27, v27, v27 quad_perm:[1,0,3,2] row_mask:0xf bank_mask:0xf
  v_add_f32_dpp v16, v16, v16 quad_perm:[2,3,0,1] row_mask:0xf bank_mask:0xf
  v_add_f32_dpp v17, v17, v17 quad_perm:[2,3,0,1] row_mask:0xf bank_mask:0xf
  v_add_f32_dpp v18, v18, v18 quad_perm:[2,3,0,1] row_mask:0xf bank_mask:0xf
  v_add_f32_dpp v19, v19, v19 quad_perm:[2,3,0,1] row_mask:0xf bank_mask:0xf
  v_add_f32_dpp v24, v24, v24 quad_perm:[2,3,0,1] row_mask:0xf bank_mask:0xf
  v_add_f32_dpp v25, v25, v25 quad_perm:[2,3,0,1] row_mask:0xf bank_mask:0xf
  v_add_f32_dpp v26, v26, v26 quad_perm:[2,3,0,1] row_mask:0xf bank_mask:0xf
  v_add_f32_dpp v27, v27, v27 quad_perm:[2,3,0,1] row_mask:0xf bank_mask:0xf
  v_add_f32_dpp v16, v16, v16 row_half_mirror row_mask:0xf bank_mask:0xf
  v_add_f32_dpp v17, v17, v17 row_half_mirror row_mask:0xf bank_mask:0xf
  v_add_f32_dpp v18, v18, v18 row_half_mirror row_mask:0xf bank_mask:0xf
  v_add_f32_dpp v19, v19, v19 row_half_mirror row_mask:0xf bank_mask:0xf
  v_add_f32_dpp v24, v24, v24 row_half_mirror row_mask:0xf bank_mask:0xf
  v_add_f32_dpp v25, v25, v25 row_half_mirror row_mask:0xf bank_mask:0xf
  v_add_f32_dpp v26, v26, v26 row_half_mirror row_mask:0xf bank_mask:0xf
  v_add_f32_dpp v27, v27, v27 row_half_mirror row_mask:0xf bank_mask:0xf
  v_cvt_pk_bf16_f32 v20, v16, v17
  v_lshlrev_b32 v16, 16, v20
  v_and_b32 v17, s70, v20
  v_cvt_pk_bf16_f32 v21, v18, v19
  v_lshlrev_b32 v18, 16, v21
  v_and_b32 v19, s70, v21
  v_cvt_pk_bf16_f32 v20, v24, v25
  v_lshlrev_b32 v24, 16, v20
  v_and_b32 v25, s70, v20
  v_cvt_pk_bf16_f32 v21, v26, v27
  v_lshlrev_b32 v26, 16, v21
  v_and_b32 v27, s70, v21
  v_mul_f32 v20, 0xbfb8aa3b, v16
  v_mul_f32 v21, 0xbfb8aa3b, v17
  v_mul_f32 v22, 0xbfb8aa3b, v18
  v_mul_f32 v23, 0xbfb8aa3b, v19
  v_exp_f32 v20, v20
  v_exp_f32 v21, v21
  v_exp_f32 v22, v22
  v_exp_f32 v23, v23
  v_add_f32 v20, 1.0, v20
  v_add_f32 v21, 1.0, v21
  v_add_f32 v22, 1.0, v22
  v_add_f32 v23, 1.0, v23
  v_rcp_f32 v20, v20
  v_rcp_f32 v21, v21
  v_rcp_f32 v22, v22
  v_rcp_f32 v23, v23
  v_mul_f32 v16, v16, v20
  v_mul_f32 v17, v17, v21
  v_mul_f32 v18, v18, v22
  v_mul_f32 v19, v19, v23
  v_cvt_pk_bf16_f32 v20, v16, v17
  v_lshlrev_b32 v16, 16, v20
  v_and_b32 v17, s70, v20
  v_cvt_pk_bf16_f32 v21, v18, v19
  v_lshlrev_b32 v18, 16, v21
  v_and_b32 v19, s70, v21
  v_mul_f32 v16, v16, v24
  v_mul_f32 v17, v17, v25
  v_mul_f32 v18, v18, v26
  v_mul_f32 v19, v19, v27
  v_cvt_pk_bf16_f32 v16, v16, v17
  v_cvt_pk_bf16_f32 v17, v18, v19
  s_mov_b32 exec_lo, 0x1010101
  s_mov_b32 exec_hi, 0x1010101
  ds_write_b64 v14, v[16:17]
  s_mov_b64 exec, -1
  s_waitcnt lgkmcnt(0)
  s_barrier
  s_branch L_DONE
DN_75:
  s_barrier
  ds_read_b128 v[24:27], v15
  s_waitcnt lgkmcnt(0)
  v_mfma_f32_16x16x32_bf16 v[32:35], v[64:67], v[24:27], 0
  v_mfma_f32_16x16x32_bf16 v[36:39], v[68:71], v[24:27], 0
  v_mfma_f32_16x16x32_bf16 v[40:43], v[72:75], v[24:27], 0
  v_mfma_f32_16x16x32_bf16 v[44:47], v[76:79], v[24:27], 0
  v_mfma_f32_16x16x32_bf16 v[48:51], v[80:83], v[24:27], 0
  v_mfma_f32_16x16x32_bf16 v[52:55], v[84:87], v[24:27], 0
  v_mfma_f32_16x16x32_bf16 v[56:59], v[88:91], v[24:27], 0
  v_mfma_f32_16x16x32_bf16 v[60:63], v[92:95], v[24:27], 0
  s_mov_b64 exec, s[74:75]
  v_add_u32 v32, 0x80, v32
  v_add_u32 v33, 0x80, v33
  v_add_u32 v34, 0x80, v34
  v_add_u32 v35, 0x80, v35
  v_and_or_b32 v32, v32, v9, s60
  v_and_or_b32 v33, v33, v9, s61
  v_and_or_b32 v34, v34, v9, s62
  v_and_or_b32 v35, v35, v9, s63
  s_add_u32 s11, s12, 0
  buffer_store_dwordx4 v[32:35], v8, s[52:55], s11 offen sc1
  v_add_u32 v36, 0x80, v36
  v_add_u32 v37, 0x80, v37
  v_add_u32 v38, 0x80, v38
  v_add_u32 v39, 0x80, v39
  v_and_or_b32 v36, v36, v9, s60
  v_and_or_b32 v37, v37, v9, s61
  v_and_or_b32 v38, v38, v9, s62
  v_and_or_b32 v39, v39, v9, s63
  s_add_u32 s11, s12, 14336
  buffer_store_dwordx4 v[36:39], v8, s[52:55], s11 offen sc1
  v_add_u32 v40, 0x80, v40
  v_add_u32 v41, 0x80, v41
  v_add_u32 v42, 0x80, v42
  v_add_u32 v43, 0x80, v43
  v_and_or_b32 v40, v40, v9, s60
  v_and_or_b32 v41, v41, v9, s61
  v_and_or_b32 v42, v42, v9, s62
  v_and_or_b32 v43, v43, v9, s63
  s_add_u32 s11, s12, 28672
  buffer_store_dwordx4 v[40:43], v8, s[52:55], s11 offen sc1
  v_add_u32 v44, 0x80, v44
  v_add_u32 v45, 0x80, v45
  v_add_u32 v46, 0x80, v46
  v_add_u32 v47, 0x80, v47
  v_and_or_b32 v44, v44, v9, s60
  v_and_or_b32 v45, v45, v9, s61
  v_and_or_b32 v46, v46, v9, s62
  v_and_or_b32 v47, v47, v9, s63
  s_add_u32 s11, s12, 43008
  buffer_store_dwordx4 v[44:47], v8, s[52:55], s11 offen sc1
  v_add_u32 v48, 0x80, v48
  v_add_u32 v49, 0x80, v49
  v_add_u32 v50, 0x80, v50
  v_add_u32 v51, 0x80, v51
  v_and_or_b32 v48, v48, v9, s60
  v_and_or_b32 v49, v49, v9, s61
  v_and_or_b32 v50, v50, v9, s62
  v_and_or_b32 v51, v51, v9, s63
  s_add_u32 s11, s12, 57344
  buffer_store_dwordx4 v[48:51], v8, s[52:55], s11 offen sc1
  v_add_u32 v52, 0x80, v52
  v_add_u32 v53, 0x80, v53
  v_add_u32 v54, 0x80, v54
  v_add_u32 v55, 0x80, v55
  v_and_or_b32 v52, v52, v9, s60
  v_and_or_b32 v53, v53, v9, s61
  v_and_or_b32 v54, v54, v9, s62
  v_and_or_b32 v55, v55, v9, s63
  s_add_u32 s11, s12, 71680
  buffer_store_dwordx4 v[52:55], v8, s[52:55], s11 offen sc1
  v_add_u32 v56, 0x80, v56
  v_add_u32 v57, 0x80, v57
  v_add_u32 v58, 0x80, v58
  v_add_u32 v59, 0x80, v59
  v_and_or_b32 v56, v56, v9, s60
  v_and_or_b32 v57, v57, v9, s61
  v_and_or_b32 v58, v58, v9, s62
  v_and_or_b32 v59, v59, v9, s63
  s_add_u32 s11, s12, 86016
  buffer_store_dwordx4 v[56:59], v8, s[52:55], s11 offen sc1
  v_add_u32 v60, 0x80, v60
  v_add_u32 v61, 0x80, v61
  v_add_u32 v62, 0x80, v62
  v_add_u32 v63, 0x80, v63
  v_and_or_b32 v60, v60, v9, s60
  v_and_or_b32 v61, v61, v9, s61
  v_and_or_b32 v62, v62, v9, s62
  v_and_or_b32 v63, v63, v9, s63
  s_add_u32 s11, s12, 100352
  buffer_store_dwordx4 v[60:63], v8, s[52:55], s11 offen sc1
  s_mov_b64 exec, -1
  s_branch L_DONE
L_T3S:
  s_lshr_b32 s12, s6, 1
  s_and_b32 s13, s6, 1
  s_lshl_b32 s78, s12, 10
  s_lshl_b32 s79, s13, 9
  s_add_u32 s78, s78, s79
  v_lshlrev_b32 v12, 3, v0
  v_add_u32 v12, s78, v12
  v_add_u32 v11, 137216, v12
  v_add_u32 v12, 0, v12
  v_lshlrev_b32 v10, 4, v0
  s_lshl_b32 s10, s78, 1
  s_add_u32 s79, s10, 16384
  v_add_u32 v14, s79, v10
  s_add_u32 s10, s10, 786432
  s_lshl_b32 s78, s6, 3
  s_add_u32 s78, s78, 4096
  v_mov_b32 v15, s78
  s_lshl_b32 s78, s12, 4
  s_add_u32 s78, s78, 4096
  v_mov_b32 v13, s78
  s_add_u32 s11, s10, 8192
  s_add_u32 s12, s10, 16384
  s_add_u32 s13, s10, 24576
  s_add_u32 s14, s10, 32768
  s_add_u32 s15, s10, 40960
  s_add_u32 s78, s10, 49152
  s_add_u32 s79, s10, 57344
  s_mov_b32 s69, 400000
W_77:
  ds_read_b32 v48, v3 offset:28
  s_waitcnt lgkmcnt(0)
  v_cmp_gt_u32 vcc, 8, v48
  s_nop 0
  s_cbranch_vccz WD_78
  s_sleep 1
  s_sub_u32 s69, s69, 1
  s_cbranch_scc0 W_77
WD_78:
  ds_read_b64 v[64:65], v11
  ds_read_b64 v[66:67], v11 offset:4096
  ds_read_b64 v[68:69], v11 offset:8192
  ds_read_b64 v[70:71], v11 offset:16384
  s_waitcnt lgkmcnt(0)
  v_lshlrev_b32 v72, 16, v64
  v_and_b32 v73, s70, v64
  v_lshlrev_b32 v74, 16, v65
  v_and_b32 v75, s70, v65
  v_lshlrev_b32 v76, 16, v66
  v_and_b32 v77, s70, v66
  v_lshlrev_b32 v78, 16, v67
  v_and_b32 v79, s70, v67
  v_lshlrev_b32 v80, 16, v68
  v_and_b32 v81, s70, v68
  v_lshlrev_b32 v82, 16, v69
  v_and_b32 v83, s70, v69
  v_lshlrev_b32 v84, 16, v70
  v_and_b32 v85, s70, v70
  v_lshlrev_b32 v86, 16, v71
  v_and_b32 v87, s70, v71
  v_lshlrev_b32 v50, 13, v0
  s_mov_b32 s69, 400000
  s_mov_b32 exec_lo, 0xff
  s_mov_b32 exec_hi, 0x0
PP_79:
  buffer_load_dwordx4 v[16:19], v50, s[52:55], s10 offen sc1
  s_waitcnt vmcnt(0)
  v_perm_b32 v48, v17, v16, s26
  v_perm_b32 v49, v19, v18, s27
  v_or_b32 v48, v48, v49
  v_cmp_eq_u32 vcc, s0, v48
  s_nop 0
  s_bcnt1_i32_b64 s7, vcc
  s_cmp_ge_u32 s7, 6
  s_cbranch_scc1 PD_80
  s_sleep 2
  s_sub_u32 s69, s69, 1
  s_cbranch_scc0 PP_79
PD_80:
  s_mov_b64 exec, -1
  s_mov_b32 s69, 400000
  s_mov_b64 s[16:17], exec
  s_mov_b64 s[18:19], exec
  s_mov_b64 s[20:21], exec
  s_mov_b64 s[22:23], exec
  s_mov_b64 s[28:29], exec
  s_mov_b64 s[30:31], exec
  s_mov_b64 s[32:33], exec
  s_mov_b64 s[34:35], exec
G_81:
  s_mov_b64 exec, s[16:17]
  buffer_load_dwordx4 v[16:19], v10, s[52:55], s10 offen offset:0 sc1
  s_mov_b64 exec, s[18:19]
  buffer_load_dwordx4 v[20:23], v10, s[52:55], s11 offen offset:0 sc1
  s_mov_b64 exec, s[20:21]
  buffer_load_dwordx4 v[24:27], v10, s[52:55], s12 offen offset:0 sc1
  s_mov_b64 exec, s[22:23]
  buffer_load_dwordx4 v[28:31], v10, s[52:55], s13 offen offset:0 sc1
  s_mov_b64 exec, s[28:29]
  buffer_load_dwordx4 v[32:35], v10, s[52:55], s14 offen offset:0 sc1
  s_mov_b64 exec, s[30:31]
  buffer_load_dwordx4 v[36:39], v10, s[52:55], s15 offen offset:0 sc1
  s_mov_b64 exec, s[32:33]
  buffer_load_dwordx4 v[40:43], v10, s[52:55], s78 offen offset:0 sc1
  s_mov_b64 exec, s[34:35]
  buffer_load_dwordx4 v[44:47], v10, s[52:55], s79 offen offset:0 sc1
  s_waitcnt vmcnt(0)
  s_mov_b64 exec, s[16:17]
  s_cbranch_execz GS_83
  v_perm_b32 v48, v17, v16, s26
  v_perm_b32 v49, v19, v18, s27
  v_or_b32 v48, v48, v49
  v_cmp_ne_u32 s[16:17], s0, v48
GS_83:
  s_mov_b64 exec, s[18:19]
  s_cbranch_execz GS_84
  v_perm_b32 v48, v21, v20, s26
  v_perm_b32 v49, v23, v22, s27
  v_or_b32 v48, v48, v49
  v_cmp_ne_u32 s[18:19], s0, v48
GS_84:
  s_mov_b64 exec, s[20:21]
  s_cbranch_execz GS_85
  v_perm_b32 v48, v25, v24, s26
  v_perm_b32 v49, v27, v26, s27
  v_or_b32 v48, v48, v49
  v_cmp_ne_u32 s[20:21], s0, v48
GS_85:
  s_mov_b64 exec, s[22:23]
  s_cbranch_execz GS_86
  v_perm_b32 v48, v29, v28, s26
  v_perm_b32 v49, v31, v30, s27
  v_or_b32 v48, v48, v49
  v_cmp_ne_u32 s[22:23], s0, v48
GS_86:
  s_mov_b64 exec, s[28:29]
  s_cbranch_execz GS_87
  v_perm_b32 v48, v33, v32, s26
  v_perm_b32 v49, v35, v34, s27
  v_or_b32 v48, v48, v49
  v_cmp_ne_u32 s[28:29], s0, v48
GS_87:
  s_mov_b64 exec, s[30:31]
  s_cbranch_execz GS_88
  v_perm_b32 v48, v37, v36, s26
  v_perm_b32 v49, v39, v38, s27
  v_or_b32 v48, v48, v49
  v_cmp_ne_u32 s[30:31], s0, v48
GS_88:
  s_mov_b64 exec, s[32:33]
  s_cbranch_execz GS_89
  v_perm_b32 v48, v41, v40, s26
  v_perm_b32 v49, v43, v42, s27
  v_or_b32 v48, v48, v49
  v_cmp_ne_u32 s[32:33], s0, v48
GS_89:
  s_mov_b64 exec, s[34:35]
  s_cbranch_execz GS_90
  v_perm_b32 v48, v45, v44, s26
  v_perm_b32 v49, v47, v46, s27
  v_or_b32 v48, v48, v49
  v_cmp_ne_u32 s[34:35], s0, v48
GS_90:
  s_or_b64 vcc, s[16:17], s[18:19]
  s_or_b64 vcc, vcc, s[20:21]
  s_or_b64 vcc, vcc, s[22:23]
  s_or_b64 vcc, vcc, s[28:29]
  s_or_b64 vcc, vcc, s[30:31]
  s_or_b64 vcc, vcc, s[32:33]
  s_or_b64 vcc, vcc, s[34:35]
  s_cbranch_scc0 GD_82
  s_sub_u32 s69, s69, 1
  s_cbranch_scc0 G_81
GD_82:
  s_mov_b64 exec, -1
  v_and_b32 v16, s1, v16
  v_and_b32 v17, s1, v17
  v_and_b32 v18, s1, v18
  v_and_b32 v19, s1, v19
  v_and_b32 v20, s1, v20
  v_and_b32 v21, s1, v21
  v_and_b32 v22, s1, v22
  v_and_b32 v23, s1, v23
  v_and_b32 v24, s1, v24
  v_and_b32 v25, s1, v25
  v_and_b32 v26, s1, v26
  v_and_b32 v27, s1, v27
  v_and_b32 v28, s1, v28
  v_and_b32 v29, s1, v29
  v_and_b32 v30, s1, v30
  v_and_b32 v31, s1, v31
  v_and_b32 v32, s1, v32
  v_and_b32 v33, s1, v33
  v_and_b32 v34, s1, v34
  v_and_b32 v35, s1, v35
  v_and_b32 v36, s1, v36
  v_and_b32 v37, s1, v37
  v_and_b32 v38, s1, v38
  v_and_b32 v39, s1, v39
  v_and_b32 v40, s1, v40
  v_and_b32 v41, s1, v41
  v_and_b32 v42, s1, v42
  v_and_b32 v43, s1, v43
  v_and_b32 v44, s1, v44
  v_and_b32 v45, s1, v45
  v_and_b32 v46, s1, v46
  v_and_b32 v47, s1, v47
  v_pk_add_f32 v[16:17], v[16:17], v[20:21]
  v_pk_add_f32 v[18:19], v[18:19], v[22:23]
  v_pk_add_f32 v[16:17], v[16:17], v[24:25]
  v_pk_add_f32 v[18:19], v[18:19], v[26:27]
  v_pk_add_f32 v[16:17], v[16:17], v[28:29]
  v_pk_add_f32 v[18:19], v[18:19], v[30:31]
  v_pk_add_f32 v[16:17], v[16:17], v[32:33]
  v_pk_add_f32 v[18:19], v[18:19], v[34:35]
  v_pk_add_f32 v[16:17], v[16:17], v[36:37]
  v_pk_add_f32 v[18:19], v[18:19], v[38:39]
  v_pk_add_f32 v[16:17], v[16:17], v[40:41]
  v_pk_add_f32 v[18:19], v[18:19], v[42:43]
  v_pk_add_f32 v[16:17], v[16:17], v[44:45]
  v_pk_add_f32 v[18:19], v[18:19], v[46:47]
  v_cvt_pk_bf16_f32 v20, v16, v17
  v_lshlrev_b32 v16, 16, v20
  v_and_b32 v17, s70, v20
  v_cvt_pk_bf16_f32 v21, v18, v19
  v_lshlrev_b32 v18, 16, v21
  v_and_b32 v19, s70, v21
  v_mul_f32 v16, v72, v16
  v_mul_f32 v17, v73, v17
  v_mul_f32 v18, v74, v18
  v_mul_f32 v19, v75, v19
  v_cvt_pk_bf16_f32 v20, v16, v17
  v_lshlrev_b32 v16, 16, v20
  v_and_b32 v17, s70, v20
  v_cvt_pk_bf16_f32 v21, v18, v19
  v_lshlrev_b32 v18, 16, v21
  v_and_b32 v19, s70, v21
  v_add_f32 v16, v84, v16
  v_add_f32 v17, v85, v17
  v_add_f32 v18, v86, v18
  v_add_f32 v19, v87, v19
  v_cvt_pk_bf16_f32 v20, v16, v17
  v_lshlrev_b32 v16, 16, v20
  v_and_b32 v17, s70, v20
  v_cvt_pk_bf16_f32 v21, v18, v19
  v_lshlrev_b32 v18, 16, v21
  v_and_b32 v19, s70, v21
  v_add_f32 v24, v16, v17
  v_mul_f32 v25, v16, v16
  v_fmac_f32 v25, v17, v17
  v_add_f32 v24, v24, v18
  v_fmac_f32 v25, v18, v18
  v_add_f32 v24, v24, v19
  v_fmac_f32 v25, v19, v19
  ds_write_b128 v14, v[16:19]
  v_add_f32_dpp v24, v24, v24 quad_perm:[1,0,3,2] row_mask:0xf bank_mask:0xf
  v_add_f32_dpp v25, v25, v25 quad_perm:[1,0,3,2] row_mask:0xf bank_mask:0xf
  s_nop 0
  v_add_f32_dpp v24, v24, v24 quad_perm:[2,3,0,1] row_mask:0xf bank_mask:0xf
  v_add_f32_dpp v25, v25, v25 quad_perm:[2,3,0,1] row_mask:0xf bank_mask:0xf
  s_nop 0
  v_add_f32_dpp v24, v24, v24 row_half_mirror row_mask:0xf bank_mask:0xf
  v_add_f32_dpp v25, v25, v25 row_half_mirror row_mask:0xf bank_mask:0xf
  s_nop 0
  v_add_f32_dpp v24, v24, v24 row_mirror row_mask:0xf bank_mask:0xf
  v_add_f32_dpp v25, v25, v25 row_mirror row_mask:0xf bank_mask:0xf
  v_mov_b32 v26, v24
  v_mov_b32 v27, v25
  s_nop 0
  v_permlane16_swap_b32 v24, v26
  v_permlane16_swap_b32 v25, v27
  v_add_f32 v24, v24, v26
  v_add_f32 v25, v25, v27
  v_mov_b32 v26, v24
  v_mov_b32 v27, v25
  s_nop 0
  v_permlane32_swap_b32 v24, v26
  v_permlane32_swap_b32 v25, v27
  v_add_f32 v24, v24, v26
  v_add_f32 v25, v25, v27
  s_mov_b64 exec, 1
  ds_write_b64 v15, v[24:25]
  s_mov_b64 exec, -1
  s_waitcnt lgkmcnt(0)
  s_barrier
  ds_read_b128 v[24:27], v13
  s_waitcnt lgkmcnt(0)
  v_pk_add_f32 v[24:25], v[24:25], v[26:27]
  v_mul_f32 v24, 0x3b000000, v24
  v_mul_f32 v25, 0x3b000000, v25
  v_fma_f32 v25, -v24, v24, v25
  v_max_f32 v25, 0, v25
  v_cvt_pk_bf16_f32 v26, v24, v25
  v_lshlrev_b32 v24, 16, v26
  v_and_b32 v25, s70, v26
  v_add_f32 v25, 0x3727c5ac, v25
  v_cvt_pk_bf16_f32 v26, v25, v25
  v_lshlrev_b32 v25, 16, v26
  v_sqrt_f32 v25, v25
  s_nop 0
  v_cvt_pk_bf16_f32 v26, v25, v25
  v_lshlrev_b32 v25, 16, v26
  v_rcp_f32 v25, v25
  v_sub_f32 v20, v16, v24
  v_sub_f32 v21, v17, v24
  v_sub_f32 v22, v18, v24
  v_sub_f32 v23, v19, v24
  v_cvt_pk_bf16_f32 v26, v20, v21
  v_lshlrev_b32 v20, 16, v26
  v_and_b32 v21, s70, v26
  v_cvt_pk_bf16_f32 v27, v22, v23
  v_lshlrev_b32 v22, 16, v27
  v_and_b32 v23, s70, v27
  v_mul_f32 v20, v20, v25
  v_mul_f32 v21, v21, v25
  v_mul_f32 v22, v22, v25
  v_mul_f32 v23, v23, v25
  v_cvt_pk_bf16_f32 v26, v20, v21
  v_lshlrev_b32 v20, 16, v26
  v_and_b32 v21, s70, v26
  v_cvt_pk_bf16_f32 v27, v22, v23
  v_lshlrev_b32 v22, 16, v27
  v_and_b32 v23, s70, v27
  v_mul_f32 v20, v20, v80
  v_mul_f32 v21, v21, v81
  v_mul_f32 v22, v22, v82
  v_mul_f32 v23, v23, v83
  v_cvt_pk_bf16_f32 v26, v20, v21
  v_lshlrev_b32 v20, 16, v26
  v_and_b32 v21, s70, v26
  v_cvt_pk_bf16_f32 v27, v22, v23
  v_lshlrev_b32 v22, 16, v27
  v_and_b32 v23, s70, v27
  v_add_f32 v20, v20, v76
  v_add_f32 v21, v21, v77
  v_add_f32 v22, v22, v78
  v_add_f32 v23, v23, v79
  v_cvt_pk_bf16_f32 v20, v20, v21
  v_cvt_pk_bf16_f32 v21, v22, v23
  ds_write_b64 v12, v[20:21]
  s_cmp_ge_u32 s3, 4
  s_cbranch_scc1 L_T2X
  s_cmp_ge_u32 s5, 12
  s_cbranch_scc1 L_T2X
  s_lshl_b32 s12, s4, 2
  s_add_u32 s12, s12, s5
  s_sub_u32 s12, s12, 8
  s_lshr_b32 s13, s12, 3
  s_and_b32 s14, s12, 7
  v_lshrrev_b32 v10, 2, v0
  v_lshlrev_b32 v10, 8, v10
  v_and_b32 v11, 3, v0
  v_lshl_add_u32 v10, v11, 4, v10
  s_mul_i32 s10, s12, 14336
  s_lshl_b32 s11, s3, 6
  s_add_u32 s10, s10, s11
  s_add_u32 s10, s10, 1048576
  s_add_u32 s11, s10, 4096
  s_add_u32 s15, s10, 8192
  s_add_u32 s7, s10, 10240
  s_lshl_b32 s78, s13, 7
  s_lshl_b32 s79, s3, 5
  s_add_u32 s78, s78, s79
  s_lshl_b32 s79, s14, 2
  s_add_u32 s78, s78, s79
  s_lshl_b32 s79, s78, 2
  s_add_u32 s79, s79, 16384
  v_lshlrev_b32 v12, 11, v11
  v_add_u32 v12, s79, v12
  ds_read_b128 v[36:39], v12
  s_lshl_b32 s79, s78, 1
  s_add_u32 s79, s79, 149504
  v_lshlrev_b32 v12, 10, v11
  v_add_u32 v12, s79, v12
  ds_read_b64 v[40:41], v12
  s_lshl_b32 s78, s13, 7
  s_lshl_b32 s79, s3, 5
  s_add_u32 s78, s78, s79
  s_add_u32 s78, s78, s14
  s_lshl_b32 s8, s78, 1
  v_lshlrev_b32 v12, 10, v11
  s_waitcnt lgkmcnt(0)
  s_barrier
  s_barrier
  s_barrier
  v_lshlrev_b32 v44, 16, v40
  v_and_b32 v45, s70, v40
  v_lshlrev_b32 v46, 16, v41
  v_and_b32 v47, s70, v41
  s_mov_b32 s56, s38
  s_mov_b32 s57, s39
  s_mov_b32 s58, 0x1000
  s_mov_b32 s59, 0x20000
  s_sleep 16
  s_mov_b32 s69, 400000
  buffer_load_dwordx4 v[64:67], v10, s[52:55], s10 offen offset:0 sc1
  buffer_load_dwordx4 v[68:71], v10, s[52:55], s11 offen offset:0 sc1
  buffer_load_dwordx4 v[72:75], v10, s[52:55], s15 offen offset:0 sc1
  buffer_load_dwordx4 v[76:79], v10, s[52:55], s7 offen offset:0 sc1
  s_sleep 12
  buffer_load_dwordx4 v[80:83], v10, s[52:55], s10 offen offset:0 sc1
  buffer_load_dwordx4 v[84:87], v10, s[52:55], s11 offen offset:0 sc1
  buffer_load_dwordx4 v[88:91], v10, s[52:55], s15 offen offset:0 sc1
  buffer_load_dwordx4 v[92:95], v10, s[52:55], s7 offen offset:0 sc1
GP_91:
  s_waitcnt vmcnt(4)
  v_perm_b32 v48, v65, v64, s26
  v_perm_b32 v49, v67, v66, s27
  v_or_b32 v48, v48, v49
  v_cmp_ne_u32 s[16:17], s0, v48
  v_perm_b32 v48, v69, v68, s26
  v_perm_b32 v49, v71, v70, s27
  v_or_b32 v48, v48, v49
  v_cmp_ne_u32 s[18:19], s0, v48
  v_perm_b32 v48, v73, v72, s26
  v_perm_b32 v49, v75, v74, s27
  v_or_b32 v48, v48, v49
  v_cmp_ne_u32 s[20:21], s0, v48
  v_perm_b32 v48, v77, v76, s26
  v_perm_b32 v49, v79, v78, s27
  v_or_b32 v48, v48, v49
  v_cmp_ne_u32 s[22:23], s0, v48
  s_or_b64 vcc, s[16:17], s[18:19]
  s_or_b64 vcc, vcc, s[20:21]
  s_or_b64 vcc, vcc, s[22:23]
  s_cbranch_scc0 GPS_93
  buffer_load_dwordx4 v[64:67], v10, s[52:55], s10 offen offset:0 sc1
  buffer_load_dwordx4 v[68:71], v10, s[52:55], s11 offen offset:0 sc1
  buffer_load_dwordx4 v[72:75], v10, s[52:55], s15 offen offset:0 sc1
  buffer_load_dwordx4 v[76:79], v10, s[52:55], s7 offen offset:0 sc1
  s_waitcnt vmcnt(4)
  v_perm_b32 v48, v81, v80, s26
  v_perm_b32 v49, v83, v82, s27
  v_or_b32 v48, v48, v49
  v_cmp_ne_u32 s[16:17], s0, v48
  v_perm_b32 v48, v85, v84, s26
  v_perm_b32 v49, v87, v86, s27
  v_or_b32 v48, v48, v49
  v_cmp_ne_u32 s[18:19], s0, v48
  v_perm_b32 v48, v89, v88, s26
  v_perm_b32 v49, v91, v90, s27
  v_or_b32 v48, v48, v49
  v_cmp_ne_u32 s[20:21], s0, v48
  v_perm_b32 v48, v93, v92, s26
  v_perm_b32 v49, v95, v94, s27
  v_or_b32 v48, v48, v49
  v_cmp_ne_u32 s[22:23], s0, v48
  s_or_b64 vcc, s[16:17], s[18:19]
  s_or_b64 vcc, vcc, s[20:21]
  s_or_b64 vcc, vcc, s[22:23]
  s_cbranch_scc0 GPS_94
  buffer_load_dwordx4 v[80:83], v10, s[52:55], s10 offen offset:0 sc1
  buffer_load_dwordx4 v[84:87], v10, s[52:55], s11 offen offset:0 sc1
  buffer_load_dwordx4 v[88:91], v10, s[52:55], s15 offen offset:0 sc1
  buffer_load_dwordx4 v[92:95], v10, s[52:55], s7 offen offset:0 sc1
  s_sub_u32 s69, s69, 1
  s_cbranch_scc0 GP_91
GPS_93:
  v_and_b32 v16, s1, v64
  v_and_b32 v17, s1, v65
  v_and_b32 v18, s1, v66
  v_and_b32 v19, s1, v67
  v_and_b32 v20, s1, v68
  v_and_b32 v21, s1, v69
  v_and_b32 v22, s1, v70
  v_and_b32 v23, s1, v71
  v_and_b32 v24, s1, v72
  v_and_b32 v25, s1, v73
  v_and_b32 v26, s1, v74
  v_and_b32 v27, s1, v75
  v_and_b32 v28, s1, v76
  v_and_b32 v29, s1, v77
  v_and_b32 v30, s1, v78
  v_and_b32 v31, s1, v79
  s_branch GPD_92
GPS_94:
  v_and_b32 v16, s1, v80
  v_and_b32 v17, s1, v81
  v_and_b32 v18, s1, v82
  v_and_b32 v19, s1, v83
  v_and_b32 v20, s1, v84
  v_and_b32 v21, s1, v85
  v_and_b32 v22, s1, v86
  v_and_b32 v23, s1, v87
  v_and_b32 v24, s1, v88
  v_and_b32 v25, s1, v89
  v_and_b32 v26, s1, v90
  v_and_b32 v27, s1, v91
  v_and_b32 v28, s1, v92
  v_and_b32 v29, s1, v93
  v_and_b32 v30, s1, v94
  v_and_b32 v31, s1, v95
GPD_92:
  v_pk_add_f32 v[16:17], v[16:17], v[20:21]
  v_pk_add_f32 v[18:19], v[18:19], v[22:23]
  v_pk_add_f32 v[16:17], v[16:17], v[24:25]
  v_pk_add_f32 v[18:19], v[18:19], v[26:27]
  s_mov_b32 exec_lo, 0x0
  s_mov_b32 exec_hi, 0xffffffff
  v_pk_add_f32 v[16:17], v[16:17], v[28:29]
  v_pk_add_f32 v[18:19], v[18:19], v[30:31]
  s_mov_b64 exec, -1
  v_add_f32_dpp v16, v16, v16 row_ror:4 row_mask:0xf bank_mask:0xf
  v_add_f32_dpp v17, v17, v17 row_ror:4 row_mask:0xf bank_mask:0xf
  v_add_f32_dpp v18, v18, v18 row_ror:4 row_mask:0xf bank_mask:0xf
  v_add_f32_dpp v19, v19, v19 row_ror:4 row_mask:0xf bank_mask:0xf
  v_add_f32_dpp v16, v16, v16 row_ror:8 row_mask:0xf bank_mask:0xf
  v_add_f32_dpp v17, v17, v17 row_ror:8 row_mask:0xf bank_mask:0xf
  v_add_f32_dpp v18, v18, v18 row_ror:8 row_mask:0xf bank_mask:0xf
  v_add_f32_dpp v19, v19, v19 row_ror:8 row_mask:0xf bank_mask:0xf
  v_mov_b32 v20, v16
  v_mov_b32 v21, v17
  v_mov_b32 v22, v18
  v_mov_b32 v23, v19
  v_permlane16_swap_b32 v16, v20
  v_permlane16_swap_b32 v17, v21
  v_permlane16_swap_b32 v18, v22
  v_permlane16_swap_b32 v19, v23
  v_add_f32 v16, v16, v20
  v_add_f32 v17, v17, v21
  v_add_f32 v18, v18, v22
  v_add_f32 v19, v19, v23
  v_mov_b32 v20, v16
  v_mov_b32 v21, v17
  v_mov_b32 v22, v18
  v_mov_b32 v23, v19
  v_permlane32_swap_b32 v16, v20
  v_permlane32_swap_b32 v17, v21
  v_permlane32_swap_b32 v18, v22
  v_permlane32_swap_b32 v19, v23
  v_add_f32 v16, v16, v20
  v_add_f32 v17, v17, v21
  v_add_f32 v18, v18, v22
  v_add_f32 v19, v19, v23
  v_cvt_pk_bf16_f32 v20, v16, v17
  v_lshlrev_b32 v16, 16, v20
  v_and_b32 v17, s70, v20
  v_cvt_pk_bf16_f32 v21, v18, v19
  v_lshlrev_b32 v18, 16, v21
  v_and_b32 v19, s70, v21
  v_mul_f32 v16, v44, v16
  v_mul_f32 v17, v45, v17
  v_mul_f32 v18, v46, v18
  v_mul_f32 v19, v47, v19
  v_cvt_pk_bf16_f32 v20, v16, v17
  v_lshlrev_b32 v16, 16, v20
  v_and_b32 v17, s70, v20
  v_cvt_pk_bf16_f32 v21, v18, v19
  v_lshlrev_b32 v18, 16, v21
  v_and_b32 v19, s70, v21
  v_add_f32 v16, v36, v16
  v_add_f32 v17, v37, v17
  v_add_f32 v18, v38, v18
  v_add_f32 v19, v39, v19
  v_cvt_pk_bf16_f32 v16, v16, v17
  v_cvt_pk_bf16_f32 v17, v18, v19
  s_mov_b64 exec, 15
  buffer_store_short v16, v12, s[56:59], s8 offen
  buffer_store_short_d16_hi v16, v12, s[56:59], s8 offen offset:16
  buffer_store_short v17, v12, s[56:59], s8 offen offset:32
  buffer_store_short_d16_hi v17, v12, s[56:59], s8 offen offset:48
  s_mov_b64 exec, -1
  s_or_b32 s10, s12, s3
  s_cmp_lg_u32 s10, 0
  s_cbranch_scc1 L_DONE
  s_add_u32 s10, s64, 1
  v_mov_b32 v10, s10
  v_mov_b32 v11, 0
  s_mov_b64 exec, 1
  buffer_store_dword v10, v11, s[52:55], 0 offen
  s_mov_b64 exec, -1
L_DONE:
  s_waitcnt vmcnt(0)
L_END:
  s_endpgm
.section .rodata,"a"
.p2align 6
.amdhsa_kernel adaLN_cond__gqa_block_cached__swiglu_ffn__decode_kernel
  .amdhsa_next_free_vgpr 128
  .amdhsa_next_free_sgpr 102
  .amdhsa_accum_offset 128
  .amdhsa_group_segment_fixed_size 0
  .amdhsa_kernarg_size 112
  .amdhsa_user_sgpr_count 2
  .amdhsa_user_sgpr_kernarg_segment_ptr 1
  .amdhsa_system_sgpr_workgroup_id_x 1
.end_amdhsa_kernel
```
